```python
import torch

def _softmax(x, axis=-1):
    return torch.softmax(x, dim=axis)
def _gelu(x):
    return torch.nn.functional.gelu(x, approximate="tanh")
def _silu(x):
    return torch.nn.functional.silu(x)
def _sigmoid(x):
    return torch.sigmoid(x)
def _layernorm(x, axis=-1, eps=1e-5):
    m = x.mean(dim=axis, keepdim=True)
    v = x.var(dim=axis, keepdim=True, unbiased=False)
    return (x - m) / torch.sqrt(v + eps)
def _scatter_add(tgt, idx, src, axis=0):
    return tgt.clone().index_add_(axis, idx, src)
def _segment_sum(src, seg, n):
    out = torch.zeros((n,) + src.shape[1:], dtype=src.dtype)
    return out.index_add_(0, seg, src)
def _pad(x, pw):
    flat = tuple(v for pair in reversed(pw) for v in pair)
    return torch.nn.functional.pad(x, flat)

kernel_name = 'parallel_sum__sliding_local_dilated__glu_gated_swiglu__prompt'

def setup_inputs():

    _w = (lambda a: (lambda t: t.to(torch.bfloat16) if t.is_floating_point() else t)(torch.as_tensor(a)))
    def _A_setup():
        B, S, D = 1, 2048, 512
        return {
            "x": _w((lambda *s: torch.randn(*s, dtype=torch.bfloat16) * 0.05)(B, S, D)),
            "wqkv": _w((lambda *s: torch.randn(*s, dtype=torch.bfloat16) * 0.05)(D, 3 * D)),
            "wo": _w((lambda *s: torch.randn(*s, dtype=torch.bfloat16) * 0.05)(D, D)),
        }
    _A_in = _A_setup()

    def _B_setup():
        B, S, D, F = 1, 2048, 512, 1376
        return {
            "x": _w((lambda *s: torch.randn(*s, dtype=torch.bfloat16) * 0.05)(B, S, D)),
            "w1": _w((lambda *s: torch.randn(*s, dtype=torch.bfloat16) * 0.8)(D, F) * (2.0 / D) ** 0.5),
            "w3": _w((lambda *s: torch.randn(*s, dtype=torch.bfloat16) * 0.8)(D, F) * (2.0 / D) ** 0.5),
            "w2": _w((lambda *s: torch.randn(*s, dtype=torch.bfloat16) * 0.8)(F, D) * (2.0 / F) ** 0.5),
        }
    _B_in = _B_setup()

    return {
        "A_x": _A_in["x"],
        "A_wqkv": _A_in["wqkv"],
        "A_wo": _A_in["wo"],
        "B_x": _B_in["x"],
        "B_w1": _B_in["w1"],
        "B_w3": _B_in["w3"],
        "B_w2": _B_in["w2"],
    }

def reference(A_x, A_wqkv, A_wo, B_x, B_w1, B_w3, B_w2):
    def _A_ref(x, wqkv, wo):
        B, S, D = x.shape
        H = 32; Dh = D // H
        W, dil = 8, 2
        qkv = (lambda x, *d: x.permute(*d))((x @ wqkv).reshape(B, S, 3, H, Dh), 2, 0, 3, 1, 4)
        q, k, v = qkv[0], qkv[1], qkv[2]
        scale = Dh ** -0.5
        pos = torch.arange(S)
        off = torch.arange(W) * dil
        idx = pos[:, None] - off[None, :]
        mask = idx >= 0
        idx_c = torch.where(mask, idx, 0).reshape(-1)
        kg = k[:, :, idx_c, :].reshape(B, H, S, W, Dh)
        vg = v[:, :, idx_c, :].reshape(B, H, S, W, Dh)
        logits = torch.einsum("bhsd,bhswd->bhsw", q, kg) * scale
        logits = torch.where(mask[None, None, :, :], logits, -1e9)
        attn = _softmax(logits, axis=-1)
        o = torch.einsum("bhsw,bhswd->bhsd", attn, vg)
        return (lambda x, *d: x.permute(*d))(o, 0, 2, 1, 3).reshape(B, S, D) @ wo

    def _B_ref(x, w1, w3, w2):
        gate = torch.einsum("bsd,df->bsf", x, w1)
        up = torch.einsum("bsd,df->bsf", x, w3)
        h = _silu(gate) * up
        out = torch.einsum("bsf,fd->bsd", h, w2)
        return out

    x = A_x
    xn = _layernorm(x, axis=-1)
    return x + _A_ref(xn, A_wqkv, A_wo) + _B_ref(xn, B_w1, B_w3, B_w2)
```

```asm
; @launch kernel=k1_kernel grid=(256,1,1) block=(512,1,1) lds=163840
.amdgcn_target "amdgcn-amd-amdhsa--gfx950"
.text
.globl k1_kernel
.p2align 8
.type k1_kernel,@function
k1_kernel:
    s_cmp_ge_u32 s2, 256
    s_cbranch_scc1 K1_END
    s_load_dwordx4 s[36:39], s[0:1], 0
    s_load_dwordx2 s[40:41], s[0:1], 16
    s_load_dwordx4 s[44:47], s[0:1], 32
    s_load_dwordx2 s[48:49], s[0:1], 48
    s_load_dwordx2 s[50:51], s[0:1], 72
    s_load_dwordx4 s[96:99], s[0:1], 56
    v_mov_b32 v153, v0
    v_mov_b32 v251, 0
    v_mov_b32 v244, 0
    v_mov_b32 v245, 0
    v_and_b32 v152, 63, v0
    v_lshrrev_b32 v186, 6, v0
    s_and_b32 s3, s2, 7
    v_readfirstlane_b32 s52, v186
    s_lshr_b32 s4, s2, 3
    s_and_b32 s5, s3, 1
    s_lshl_b32 s5, s5, 3
    s_and_b32 s6, s4, 7
    s_add_u32 s55, s5, s6
    s_lshr_b32 s5, s3, 1
    s_lshl_b32 s5, s5, 2
    s_lshr_b32 s6, s4, 3
    s_add_u32 s56, s5, s6
    s_mul_i32 s6, s6, 4
    s_mul_i32 s5, s4, 4
    s_add_u32 s6, s6, s5
    s_and_b32 s5, s3, 1
    s_mul_i32 s5, s5, 2
    s_add_u32 s6, s6, s5
    s_lshr_b32 s5, s3, 1
    s_mul_i32 s5, s5, 2
    s_add_u32 s6, s6, s5
    s_and_b32 s69, s6, 7
    s_lshl_b32 s68, s69, 1
    s_lshl_b32 s57, s55, 7
    s_and_b32 s53, s52, 3
    s_lshr_b32 s54, s52, 2
    s_lshr_b32 s3, s56, 1
    s_mul_i32 s3, s3, 11
    s_and_b32 s4, s56, 1
    s_mul_i32 s5, s56, 5
    s_add_u32 s5, s5, 6
    s_cmp_lt_u32 s56, 12
    s_cselect_b32 s3, s3, s5
    s_cselect_b32 s63, s4, 0
    s_cselect_b32 s64, 1, 0
    s_add_u32 s59, s3, 5
    s_mul_i32 s4, s63, 6
    s_add_u32 s58, s3, s4
    s_lshl_b32 s5, s3, 5
    s_mul_i32 s4, s63, 176
    s_add_u32 s60, s5, s4
    s_lshl_b32 s61, s63, 4
    s_mul_i32 s4, s63, 160
    s_sub_u32 s62, 160, s4
    v_mul_u32_u24 v186, 43691, v153
    v_lshrrev_b32 v186, 19, v186
    v_mul_u32_u24 v187, 12, v186
    v_sub_u32 v187, v153, v187
    v_mul_u32_u24 v154, 2752, v186
    v_lshl_add_u32 v154, v187, 4, v154
    v_add_u32 v154, s60, v154
    v_mul_u32_u24 v155, 3072, v186
    v_lshrrev_b32 v188, 2, v187
    v_lshl_add_u32 v155, v188, 10, v155
    v_and_b32 v188, 3, v187
    v_lshl_add_u32 v155, v188, 4, v155
    s_lshl_b32 s3, s56, 6
    v_add_u32 v155, s3, v155
    s_mul_i32 s3, s52, 24
    v_lshrrev_b32 v186, 3, v152
    v_add_u32 v186, s3, v186
    v_and_b32 v187, 7, v152
    s_sub_u32 s4, s57, 16
    v_bfe_u32 v189, v186, 1, 3
    v_xor_b32 v189, v189, v187
    v_add_u32 v188, s4, v186
    v_lshlrev_b32 v190, 10, v188
    v_lshl_add_u32 v156, v189, 4, v190
    v_xor_b32 v157, 64, v156
    v_add_u32 v157, 0x2000, v157
    v_add_u32 v158, 0x4000, v156
    v_min_u32 v156, 0x80000000, v156
    v_min_u32 v157, 0x80000000, v157
    s_lshl_b32 s81, s2, 3
    s_add_u32 s81, s81, s52
    s_lshr_b32 s3, s81, 4
    s_and_b32 s4, s81, 15
    s_sub_u32 s5, s3, 32
    s_cmp_lt_u32 s3, 32
    s_cselect_b32 s5, s3, s5
    s_cselect_b32 s74, 1, 0
    s_lshl_b32 s5, s5, 14
    s_lshl_b32 s4, s4, 6
    s_add_u32 s5, s5, s4
    v_lshrrev_b32 v186, 2, v152
    v_lshlrev_b32 v186, 10, v186
    v_and_b32 v187, 3, v152
    v_lshl_add_u32 v186, v187, 4, v186
    v_add_u32 v192, s5, v186
    s_lshl_b32 s88, s52, 10
    s_mul_i32 s89, s52, 3072
    s_add_u32 s89, s89, 92544
    s_mov_b32 s83, s88
    s_mov_b32 s85, s88
    s_mov_b32 s84, s89
    s_waitcnt lgkmcnt(0)
    s_mov_b32 s8, s36
    s_and_b32 s9, s37, 0xffff
    s_mov_b32 s10, 2097152
    s_mov_b32 s11, 0x00020000
    s_mov_b32 s20, s38
    s_and_b32 s21, s39, 0xffff
    s_mov_b32 s22, 1572864
    s_mov_b32 s23, 0x00020000
    s_mov_b32 s12, s44
    s_and_b32 s13, s45, 0xffff
    s_mov_b32 s14, 1409024
    s_mov_b32 s15, 0x00020000
    s_mov_b32 s16, s46
    s_and_b32 s17, s47, 0xffff
    s_mov_b32 s18, 1409024
    s_mov_b32 s19, 0x00020000
    s_cmp_eq_u32 s74, 1
    s_cselect_b32 s24, s40, s48
    s_cselect_b32 s25, s41, s49
    s_mov_b32 s3, 1409024
    s_cselect_b32 s26, 524288, s3
    s_and_b32 s25, s25, 0xffff
    s_mov_b32 s27, 0x00020000
    buffer_load_dwordx4 v[200:203], v192, s[24:27], 0 offen
    s_cmp_lt_u32 s52, 6
    s_cselect_b32 s78, 1, 0
    s_cbranch_scc0 K1_PRO_PF
    s_mul_i32 s70, s68, 88064
    s_mul_i32 s71, s68, 98304
    s_add_u32 m0, s83, 0
    s_add_u32 s68, s68, 1
    buffer_load_dwordx4 v154, s[12:15], s70 offen lds
    s_add_u32 m0, s83, 6144
    s_and_b32 s68, s68, 15
    buffer_load_dwordx4 v155, s[20:23], s71 offen lds
    s_add_u32 m0, s83, 12320
    s_add_u32 s83, s83, 18496
    buffer_load_dwordx4 v154, s[16:19], s70 offen lds
    s_cmp_ge_u32 s83, 55488
    s_cselect_b32 s83, s85, s83
    s_lshl_b32 s72, s69, 7
    s_add_u32 m0, s84, 0
    s_add_u32 s69, s69, 1
    buffer_load_dwordx4 v156, s[8:11], s72 offen lds
    s_add_u32 m0, s84, 1024
    s_and_b32 s69, s69, 7
    buffer_load_dwordx4 v157, s[8:11], s72 offen lds
    s_add_u32 m0, s84, 2048
    s_add_u32 s84, s84, 18432
    buffer_load_dwordx4 v158, s[8:11], s72 offen lds
    s_cmp_ge_u32 s84, 129408
    s_cselect_b32 s84, s89, s84
    s_branch K1_PRO_NODMA0
K1_PRO_PF:
    s_mov_b32 s44, s98
    s_and_b32 s45, s99, 0xffff
    s_mov_b32 s46, 256
    s_mov_b32 s47, 0x00020000
    s_lshl_b32 s3, s56, 6
    s_lshl_b32 s4, s55, 2
    s_add_u32 s3, s3, s4
    v_mov_b32 v244, s3
    v_lshlrev_b32 v245, 4, v152
    s_lshr_b32 s3, s2, 3
    s_lshl_b32 s3, s3, 3
    s_add_u32 s3, s3, s52
    s_cmp_eq_u32 s3, 7
    s_cbranch_scc0 K1_PRO_NODMA0
    s_memrealtime s[100:101]
    s_waitcnt lgkmcnt(0)
    s_or_b32 s100, s100, 1
    v_mov_b32 v250, s100
    s_mov_b64 exec, 1
    buffer_atomic_cmpswap v[250:251], v251, s[44:47], 0 offen sc1
    s_mov_b64 exec, -1
K1_PRO_NODMA0:
    s_barrier
    s_cmp_eq_u32 s78, 1
    s_cbranch_scc0 K1_PRO_NODMA1
    s_mul_i32 s70, s68, 88064
    s_mul_i32 s71, s68, 98304
    s_add_u32 m0, s83, 0
    s_add_u32 s68, s68, 1
    buffer_load_dwordx4 v154, s[12:15], s70 offen lds
    s_add_u32 m0, s83, 6144
    s_and_b32 s68, s68, 15
    buffer_load_dwordx4 v155, s[20:23], s71 offen lds
    s_add_u32 m0, s83, 12320
    s_add_u32 s83, s83, 18496
    buffer_load_dwordx4 v154, s[16:19], s70 offen lds
    s_cmp_ge_u32 s83, 55488
    s_cselect_b32 s83, s85, s83
    s_branch K1_PRO_DMA1
K1_PRO_NODMA1:
    s_mov_b32 s10, 0
    s_mov_b32 s14, 0
    s_mov_b32 s18, 0
    s_mov_b32 s22, 0
    s_mov_b32 s83, 55488
    s_mov_b32 s84, 129408
    s_mov_b32 s85, 55488
    s_mov_b32 s89, 129408
K1_PRO_DMA1:
    s_mov_b32 s28, s50
    s_and_b32 s29, s51, 0xffff
    s_mov_b32 s30, 7733248
    s_mov_b32 s31, 0x00020000
    s_add_u32 s32, s50, 8388608
    s_addc_u32 s33, s51, 0
    s_and_b32 s33, s33, 0xffff
    s_mov_b32 s34, 1933312
    s_mov_b32 s35, 0x00020000
    s_add_u32 s40, s50, 12582912
    s_addc_u32 s41, s51, 0
    s_and_b32 s41, s41, 0xffff
    s_mov_b32 s42, 8192
    s_mov_b32 s43, 0x00020000
    v_mov_b32 v194, 0x3f803f80
    v_mov_b32 v195, 0x3f803f80
    v_mov_b32 v196, 0x3f803f80
    v_mov_b32 v197, 0x3f803f80
    v_mov_b32 v190, 147840
    ds_write_b128 v190, v[194:197]
    ds_write_b64 v190, v[194:195] offset:768
    ds_write_b64 v190, v[194:195] offset:3072
    ds_write_b64 v190, v[194:195] offset:3840
    v_and_b32 v186, 31, v152
    v_lshrrev_b32 v187, 5, v152
    v_bfe_u32 v188, v152, 1, 3
    v_xor_b32 v188, v188, v187
    v_lshlrev_b32 v188, 4, v188
    v_lshl_add_u32 v188, v186, 7, v188
    s_and_b32 s3, s53, 1
    s_lshl_b32 s4, s54, 1
    s_add_u32 s79, s4, s3
    s_xor_b32 s80, s79, 1
    s_lshl_b32 s3, s79, 12
    s_add_u32 s3, s3, 2048
    v_add_u32 v159, s3, v188
    s_lshl_b32 s3, s80, 12
    s_add_u32 s3, s3, 2048
    v_add_u32 v160, s3, v188
    v_bfe_u32 v186, v152, 4, 1
    v_bfe_u32 v188, v152, 2, 2
    v_lshl_add_u32 v188, v187, 3, v188
    v_mul_u32_u24 v188, 192, v188
    v_and_b32 v189, 3, v152
    v_lshl_add_u32 v190, v189, 3, v188
    v_lshl_add_u32 v191, v186, 5, v190
    v_add_u32 v191, 6144, v191
    v_mul_u32_u24 v193, 12320, v186
    v_add_u32 v193, v193, v190
    v_add_u32 v193, s61, v193
    s_lshl_b32 s3, s53, 1
    s_add_u32 s3, s3, 0
    s_lshl_b32 s4, s3, 6
    s_sub_u32 s5, s3, 3
    s_lshl_b32 s5, s5, 5
    s_cmp_lt_u32 s3, 3
    s_cselect_b32 s4, s4, s5
    s_cselect_b64 s[86:87], -1, 0
    v_cndmask_b32 v161, v193, v191, s[86:87]
    v_add_u32 v161, s4, v161
    s_lshl_b32 s3, s53, 1
    s_add_u32 s3, s3, 1
    s_lshl_b32 s4, s3, 6
    s_sub_u32 s5, s3, 3
    s_lshl_b32 s5, s5, 5
    s_cmp_lt_u32 s3, 3
    s_cselect_b32 s4, s4, s5
    s_cselect_b64 s[86:87], -1, 0
    v_cndmask_b32 v162, v193, v191, s[86:87]
    v_add_u32 v162, s4, v162
    v_lshrrev_b32 v194, 1, v189
    v_mul_u32_u24 v194, 12320, v194
    v_and_b32 v195, 1, v189
    v_lshl_add_u32 v194, v195, 3, v194
    v_add_u32 v194, v194, v188
    v_add_u32 v194, s62, v194
    v_mov_b32 v195, 147840
    v_cmp_eq_u32 vcc, 1, v186
    v_xor_b32 v164, 1, v186
    s_nop 0
    v_cndmask_b32 v163, v194, v195, vcc
    v_and_b32 v186, 15, v152
    v_lshrrev_b32 v187, 4, v152
    v_bfe_u32 v188, v152, 1, 3
    v_xor_b32 v188, v188, v187
    v_lshlrev_b32 v188, 4, v188
    v_lshl_add_u32 v165, v186, 7, v188
    s_lshl_b32 s3, s52, 11
    s_add_u32 s3, s3, 2048
    v_add_u32 v169, s3, v165
    v_cmp_eq_u32 vcc, 0, v186
    v_mov_b32 v190, 0
    v_mov_b32 v191, 1
    v_cndmask_b32 v168, v190, v195, vcc
    v_cndmask_b32 v167, v191, v190, vcc
    v_and_b32 v191, 1, v187
    v_cmp_eq_u32 vcc, v191, v186
    v_mov_b32 v191, 0x3f803f80
    s_nop 0
    v_cndmask_b32 v148, v190, v191, vcc
    v_cndmask_b32 v149, v190, v191, vcc
    v_cndmask_b32 v150, v190, v191, vcc
    v_cndmask_b32 v151, v190, v191, vcc
    v_bfe_u32 v188, v152, 2, 2
    v_lshl_add_u32 v188, v187, 3, v188
    v_mul_u32_u24 v188, 192, v188
    v_lshl_add_u32 v188, v189, 3, v188
    s_lshl_b32 s3, s53, 5
    s_add_u32 s3, s3, 6208
    v_add_u32 v166, s3, v188
    v_bfe_u32 v186, v152, 4, 1
    v_lshrrev_b32 v187, 5, v152
    v_bfe_u32 v188, v152, 2, 2
    s_cmp_eq_u32 s74, 1
    s_cselect_b32 s3, 3, 2
    s_movk_i32 s4, 512
    s_cselect_b32 s4, 256, s4
    v_lshlrev_b32 v187, s3, v187
    v_add_u32 v187, v187, v188
    v_lshlrev_b32 v187, 6, v187
    v_lshl_add_u32 v187, v186, 5, v187
    v_lshl_add_u32 v187, v189, 3, v187
    s_add_u32 s5, s88, 151936
    v_add_u32 v204, s5, v187
    v_add_u32 v205, s4, v204
    v_mov_b32 v96, 0
    v_mov_b32 v97, 0
    v_mov_b32 v98, 0
    v_mov_b32 v99, 0
    s_nop 1
    v_mfma_f32_32x32x16_bf16 v[0:15], v[96:99], v[96:99], 0
    v_mfma_f32_32x32x16_bf16 v[16:31], v[96:99], v[96:99], 0
    v_mfma_f32_32x32x16_bf16 v[32:47], v[96:99], v[96:99], 0
    v_mfma_f32_32x32x16_bf16 v[48:63], v[96:99], v[96:99], 0
    v_mfma_f32_32x32x16_bf16 v[64:79], v[96:99], v[96:99], 0
    v_mfma_f32_32x32x16_bf16 v[80:95], v[96:99], v[96:99], 0
    v_mfma_f32_32x32x16_bf16 v[100:115], v[96:99], v[96:99], 0
    v_mfma_f32_32x32x16_bf16 v[116:131], v[96:99], v[96:99], 0
    v_mfma_f32_32x32x16_bf16 v[132:147], v[96:99], v[96:99], 0
    s_mov_b32 s65, 0
    s_mov_b32 s66, 18496
    s_mov_b32 s67, 92544
    s_mov_b32 s73, 1
    s_lshr_b32 s3, s53, 1
    s_cmp_eq_u32 s3, s54
    s_cbranch_scc0 K1_ROLEH
    s_waitcnt vmcnt(9)
    s_cmp_eq_u32 s78, 1
    s_cbranch_scc1 K1_TJ1
    s_waitcnt vmcnt(0)
K1_TJ1:
    s_mul_i32 s78, s78, 7
    v_lshlrev_b32 v196, 4, v152
    s_add_u32 s3, s88, 151936
    v_add_u32 v197, s3, v196
    ds_write_b128 v197, v[200:203]
    s_waitcnt lgkmcnt(0)
    ds_read_b64_tr_b16 v[200:201], v204
    ds_read_b64_tr_b16 v[202:203], v205
    s_lshl_b32 s3, s81, 10
    s_waitcnt lgkmcnt(0)
    buffer_store_dwordx4 v[200:203], v196, s[32:35], s3 offen sc1
    v_add_u32 v170, s67, v159
    v_add_u32 v174, s67, v160
    v_xor_b32 v171, 32, v170
    v_xor_b32 v175, 32, v174
    v_xor_b32 v172, 64, v170
    v_xor_b32 v176, 64, v174
    v_xor_b32 v173, 96, v170
    v_xor_b32 v177, 96, v174
    v_add_u32 v178, s65, v161
    v_add_u32 v179, s65, v162
    v_mad_u32_u24 v180, v164, s65, v163
    v_add_u32 v184, s67, v169
K1_LOOP9:
    s_waitcnt vmcnt(3) lgkmcnt(0)
    s_barrier
    s_cmp_eq_u32 s53, 3
    s_cbranch_scc0 K1_C92
    v_mfma_f32_16x16x32_bf16 v[84:87], v[128:131], v[148:151], v[84:87]
K1_C92:
    v_mfma_f32_32x32x16_bf16 v[0:15], v[120:123], v[100:103], v[0:15]
    ds_read_b128 v[92:95], v170
    ds_read_b64_tr_b16 v[108:109], v178 offset:0
    ds_read_b64_tr_b16 v[110:111], v178 offset:768
    ds_read_b128 v[96:99], v174
    v_mfma_f32_32x32x16_bf16 v[16:31], v[120:123], v[104:107], v[16:31]
    ds_read_b64_tr_b16 v[112:113], v179 offset:0
    ds_read_b64_tr_b16 v[114:115], v179 offset:768
    ds_read_b64_tr_b16 v[116:117], v180 offset:0
    ds_read_b64_tr_b16 v[118:119], v180 offset:768
    v_mfma_f32_16x16x32_bf16 v[80:83], v[120:123], v[148:151], v[80:83]
    s_mul_i32 s70, s68, 88064
    s_mul_i32 s71, s68, 98304
    v_mfma_f32_32x32x16_bf16 v[32:47], v[124:127], v[100:103], v[32:47]
    s_add_u32 m0, s83, 0
    s_add_u32 s68, s68, 1
    buffer_load_dwordx4 v154, s[12:15], s70 offen lds
    s_add_u32 m0, s83, 6144
    v_mfma_f32_16x16x32_bf16 v[88:91], v[144:147], v[144:147], v[88:91]
    s_and_b32 s68, s68, 15
    buffer_load_dwordx4 v155, s[20:23], s71 offen lds
    v_mfma_f32_32x32x16_bf16 v[48:63], v[124:127], v[104:107], v[48:63]
    s_add_u32 m0, s83, 12320
    s_add_u32 s83, s83, 18496
    buffer_load_dwordx4 v154, s[16:19], s70 offen lds
    s_cmp_ge_u32 s83, 55488
    s_cselect_b32 s83, s85, s83
    v_mfma_f32_32x32x16_bf16 v[64:79], v[128:131], v[100:103], v[64:79]
    s_waitcnt lgkmcnt(0)
    s_cmp_eq_u32 s53, 0
    s_cbranch_scc0 K1_C93
    v_mfma_f32_16x16x32_bf16 v[84:87], v[116:119], v[148:151], v[84:87]
K1_C93:
    v_mfma_f32_32x32x16_bf16 v[0:15], v[108:111], v[92:95], v[0:15]
    ds_read_b128 v[100:103], v171
    ds_read_b64_tr_b16 v[120:121], v178 offset:3072
    ds_read_b64_tr_b16 v[122:123], v178 offset:3840
    ds_read_b128 v[104:107], v175
    ds_read_b64_tr_b16 v[124:125], v179 offset:3072
    v_mfma_f32_32x32x16_bf16 v[16:31], v[108:111], v[96:99], v[16:31]
    ds_read_b64_tr_b16 v[126:127], v179 offset:3840
    ds_read_b64_tr_b16 v[128:129], v180 offset:3072
    ds_read_b64_tr_b16 v[130:131], v180 offset:3840
    ds_read_b128 v[144:147], v184
    s_lshl_b32 s72, s69, 7
    s_add_u32 m0, s84, 0
    v_mfma_f32_16x16x32_bf16 v[80:83], v[108:111], v[148:151], v[80:83]
    s_add_u32 s69, s69, 1
    buffer_load_dwordx4 v156, s[8:11], s72 offen lds
    s_add_u32 m0, s84, 1024
    v_mfma_f32_32x32x16_bf16 v[32:47], v[112:115], v[92:95], v[32:47]
    s_and_b32 s69, s69, 7
    buffer_load_dwordx4 v157, s[8:11], s72 offen lds
    s_add_u32 m0, s84, 2048
    s_add_u32 s84, s84, 18432
    buffer_load_dwordx4 v158, s[8:11], s72 offen lds
    s_cmp_ge_u32 s84, 129408
    v_mfma_f32_32x32x16_bf16 v[48:63], v[112:115], v[96:99], v[48:63]
    s_cselect_b32 s84, s89, s84
    v_add_u32 v178, s66, v161
    v_add_u32 v179, s66, v162
    v_mad_u32_u24 v180, v164, s66, v163
    v_add_u32 v184, s67, v169
    v_xor_b32 v184, 64, v184
    v_mfma_f32_32x32x16_bf16 v[64:79], v[116:119], v[92:95], v[64:79]
    s_waitcnt vmcnt(6) lgkmcnt(0)
    s_barrier
    s_lshl_b32 s76, s73, 3
    s_add_u32 s76, s76, s52
    s_cmp_eq_u32 s76, 15
    s_cbranch_scc0 K1_S10
    buffer_load_dword v250, v251, s[44:47], 0 offen sc1
K1_S10:
    s_cmp_eq_u32 s76, 23
    s_cbranch_scc0 K1_S1A
    s_mov_b32 s3, 0
K1_S1T:
    v_readfirstlane_b32 s100, v250
    s_add_u32 s3, s3, 1
    s_cmp_gt_u32 s3, 0x20000
    s_cbranch_scc1 K1_S1U
    s_cmp_lg_u32 s100, 0
    s_cbranch_scc1 K1_S1U
    s_sleep 4
    buffer_load_dword v250, v251, s[44:47], 0 offen sc1
    s_waitcnt vmcnt(0)
    s_branch K1_S1T
K1_S1U:
    v_mov_b32 v251, 162176
    s_mov_b64 exec, 1
    ds_write_b32 v251, v250
    buffer_store_dword v250, v244, s[40:43], 0 offen sc1
    s_mov_b64 exec, -1
K1_S1A:
    s_cmp_eq_u32 s76, 71
    s_cbranch_scc0 K1_S1B
    buffer_load_dwordx4 v[246:249], v245, s[40:43], 0 offen sc1
K1_S1B:
    s_cmp_eq_u32 s53, 1
    s_cbranch_scc0 K1_C94
    v_mfma_f32_16x16x32_bf16 v[84:87], v[128:131], v[148:151], v[84:87]
K1_C94:
    v_mfma_f32_32x32x16_bf16 v[0:15], v[120:123], v[100:103], v[0:15]
    ds_read_b128 v[92:95], v172
    ds_read_b64_tr_b16 v[108:109], v178 offset:0
    ds_read_b64_tr_b16 v[110:111], v178 offset:768
    v_mfma_f32_32x32x16_bf16 v[16:31], v[120:123], v[104:107], v[16:31]
    ds_read_b128 v[96:99], v176
    ds_read_b64_tr_b16 v[112:113], v179 offset:0
    ds_read_b64_tr_b16 v[114:115], v179 offset:768
    v_mfma_f32_16x16x32_bf16 v[80:83], v[120:123], v[148:151], v[80:83]
    ds_read_b64_tr_b16 v[116:117], v180 offset:0
    ds_read_b64_tr_b16 v[118:119], v180 offset:768
    v_mfma_f32_32x32x16_bf16 v[32:47], v[124:127], v[100:103], v[32:47]
    s_mul_i32 s70, s68, 88064
    s_mul_i32 s71, s68, 98304
    s_add_u32 m0, s83, 0
    v_mfma_f32_16x16x32_bf16 v[88:91], v[144:147], v[144:147], v[88:91]
    s_add_u32 s68, s68, 1
    v_mfma_f32_32x32x16_bf16 v[48:63], v[124:127], v[104:107], v[48:63]
    buffer_load_dwordx4 v154, s[12:15], s70 offen lds
    s_add_u32 m0, s83, 6144
    s_and_b32 s68, s68, 15
    buffer_load_dwordx4 v155, s[20:23], s71 offen lds
    v_mfma_f32_32x32x16_bf16 v[64:79], v[128:131], v[100:103], v[64:79]
    s_waitcnt lgkmcnt(0)
    s_cmp_eq_u32 s53, 2
    s_cbranch_scc0 K1_C95
    v_mfma_f32_16x16x32_bf16 v[84:87], v[116:119], v[148:151], v[84:87]
K1_C95:
    v_mfma_f32_32x32x16_bf16 v[0:15], v[108:111], v[92:95], v[0:15]
    ds_read_b128 v[100:103], v173
    ds_read_b64_tr_b16 v[120:121], v178 offset:3072
    ds_read_b64_tr_b16 v[122:123], v178 offset:3840
    ds_read_b128 v[104:107], v177
    ds_read_b64_tr_b16 v[124:125], v179 offset:3072
    ds_read_b64_tr_b16 v[126:127], v179 offset:3840
    ds_read_b64_tr_b16 v[128:129], v180 offset:3072
    ds_read_b64_tr_b16 v[130:131], v180 offset:3840
    ds_read_b128 v[144:147], v184
    v_mfma_f32_32x32x16_bf16 v[16:31], v[108:111], v[96:99], v[16:31]
    s_add_u32 m0, s83, 12320
    s_add_u32 s83, s83, 18496
    buffer_load_dwordx4 v154, s[16:19], s70 offen lds
    s_cmp_ge_u32 s83, 55488
    s_cselect_b32 s83, s85, s83
    s_cmp_eq_u32 s73, 7
    s_cselect_b32 s10, 0, s10
    s_cselect_b32 s14, 0, s14
    s_cselect_b32 s18, 0, s18
    v_mfma_f32_16x16x32_bf16 v[80:83], v[108:111], v[148:151], v[80:83]
    s_cselect_b32 s22, 0, s22
    s_add_u32 s65, s65, 36992
    s_sub_u32 s75, s65, 55488
    s_cmp_ge_u32 s65, 55488
    s_cselect_b32 s65, s75, s65
    v_mfma_f32_32x32x16_bf16 v[32:47], v[112:115], v[92:95], v[32:47]
    s_add_u32 s66, s66, 36992
    s_sub_u32 s75, s66, 55488
    s_cmp_ge_u32 s66, 55488
    s_cselect_b32 s66, s75, s66
    s_add_u32 s67, s67, 18432
    s_cmp_ge_u32 s67, 129408
    s_cselect_b32 s67, 92544, s67
    v_add_u32 v170, s67, v159
    v_add_u32 v174, s67, v160
    v_mfma_f32_32x32x16_bf16 v[48:63], v[112:115], v[96:99], v[48:63]
    v_xor_b32 v171, 32, v170
    v_xor_b32 v175, 32, v174
    v_xor_b32 v172, 64, v170
    v_xor_b32 v176, 64, v174
    v_xor_b32 v173, 96, v170
    v_xor_b32 v177, 96, v174
    v_add_u32 v178, s65, v161
    v_add_u32 v179, s65, v162
    v_mad_u32_u24 v180, v164, s65, v163
    v_add_u32 v184, s67, v169
    v_mfma_f32_32x32x16_bf16 v[64:79], v[116:119], v[92:95], v[64:79]
    s_add_u32 s73, s73, 1
    s_cmp_lt_u32 s73, 9
    s_cbranch_scc1 K1_LOOP9
    s_waitcnt lgkmcnt(0)
    s_cmp_eq_u32 s53, 3
    s_cbranch_scc0 K1_C96
    v_mfma_f32_16x16x32_bf16 v[84:87], v[128:131], v[148:151], v[84:87]
K1_C96:
    v_mfma_f32_32x32x16_bf16 v[0:15], v[120:123], v[100:103], v[0:15]
    v_mfma_f32_32x32x16_bf16 v[16:31], v[120:123], v[104:107], v[16:31]
    v_mfma_f32_16x16x32_bf16 v[80:83], v[120:123], v[148:151], v[80:83]
    v_mfma_f32_32x32x16_bf16 v[32:47], v[124:127], v[100:103], v[32:47]
    v_mfma_f32_16x16x32_bf16 v[88:91], v[144:147], v[144:147], v[88:91]
    v_mfma_f32_32x32x16_bf16 v[48:63], v[124:127], v[104:107], v[48:63]
    v_mfma_f32_32x32x16_bf16 v[64:79], v[128:131], v[100:103], v[64:79]
    v_and_b32 v186, 15, v152
    v_lshrrev_b32 v187, 4, v152
    v_lshlrev_b32 v188, 6, v186
    v_lshl_add_u32 v188, v187, 4, v188
    s_lshl_b32 s3, s53, 8
    s_add_u32 s3, s3, 160128
    v_add_u32 v189, s3, v188
    s_lshl_b32 s3, s53, 7
    s_add_u32 s3, s3, 161152
    v_add_u32 v190, s3, v188
    v_and_b32 v191, 3, v152
    v_lshlrev_b32 v192, 2, v152
    s_lshl_b32 s3, s52, 8
    s_add_u32 s3, s3, 148864
    v_add_u32 v193, s3, v192
    v_cmp_eq_u32 vcc, 1, v191
    v_cmp_eq_u32 s[86:87], 2, v191
    v_cmp_eq_u32 s[4:5], 3, v191
    v_cndmask_b32 v194, v88, v89, vcc
    v_cndmask_b32 v194, v194, v90, s[86:87]
    v_cndmask_b32 v194, v194, v91, s[4:5]
    ds_write_b32 v193, v194
    v_cmp_gt_u32 vcc, 2, v186
    s_and_saveexec_b64 s[4:5], vcc
    ds_write_b128 v189, v[80:83]
    ds_write_b128 v190, v[84:87]
    s_mov_b64 exec, s[4:5]
    v_and_b32 v186, 31, v152
    v_lshlrev_b32 v186, 2, v186
    s_lshl_b32 s3, s79, 7
    s_lshl_b32 s4, s80, 7
    v_add_u32 v188, s3, v186
    v_add_u32 v189, s4, v186
    v_add_u32 v192, 161664, v188
    ds_write_b32 v192, v72
    s_mov_b32 s77, 1
    s_waitcnt vmcnt(0)
    s_cmp_eq_u32 s52, 7
    s_cbranch_scc0 K1_EPI
    s_mov_b32 s3, 0
K1_S1P:
    v_xor_b32 v246, s100, v246
    v_xor_b32 v247, s100, v247
    v_xor_b32 v248, s100, v248
    v_xor_b32 v249, s100, v249
    v_or3_b32 v246, v246, v247, v248
    v_or_b32 v246, v246, v249
    v_cmp_ne_u32 vcc, 0, v246
    s_add_u32 s3, s3, 1
    s_cmp_gt_u32 s3, 0x20000
    s_cbranch_scc1 K1_EPI
    s_cbranch_vccz K1_EPI
    s_sleep 4
    buffer_load_dwordx4 v[246:249], v245, s[40:43], 0 offen sc1
    s_waitcnt vmcnt(0)
    s_branch K1_S1P
    s_branch K1_EPI
K1_ROLEH:
    s_waitcnt vmcnt(9)
    s_cmp_eq_u32 s78, 1
    s_cbranch_scc1 K1_TJ7
    s_waitcnt vmcnt(0)
K1_TJ7:
    s_mul_i32 s78, s78, 7
    v_lshlrev_b32 v196, 4, v152
    s_add_u32 s3, s88, 151936
    v_add_u32 v197, s3, v196
    ds_write_b128 v197, v[200:203]
    s_waitcnt lgkmcnt(0)
    ds_read_b64_tr_b16 v[200:201], v204
    ds_read_b64_tr_b16 v[202:203], v205
    s_lshl_b32 s3, s81, 10
    s_waitcnt lgkmcnt(0)
    buffer_store_dwordx4 v[200:203], v196, s[32:35], s3 offen sc1
    v_add_u32 v170, s67, v159
    v_add_u32 v174, s67, v160
    v_xor_b32 v171, 32, v170
    v_xor_b32 v175, 32, v174
    v_xor_b32 v172, 64, v170
    v_xor_b32 v176, 64, v174
    v_xor_b32 v173, 96, v170
    v_xor_b32 v177, 96, v174
    v_add_u32 v178, s65, v161
    v_add_u32 v179, s65, v162
    v_add_u32 v183, s65, v166
    v_add_u32 v181, s67, v165
    v_mad_u32_u24 v182, v167, v181, v168
    v_add_u32 v184, s67, v169
K1_LOOPH:
    s_waitcnt vmcnt(3) lgkmcnt(0)
    s_barrier
    v_mfma_f32_32x32x16_bf16 v[0:15], v[120:123], v[100:103], v[0:15]
    ds_read_b128 v[92:95], v170
    ds_read_b64_tr_b16 v[108:109], v178 offset:0
    ds_read_b64_tr_b16 v[110:111], v178 offset:768
    v_mfma_f32_32x32x16_bf16 v[16:31], v[120:123], v[104:107], v[16:31]
    ds_read_b128 v[96:99], v174
    ds_read_b64_tr_b16 v[112:113], v179 offset:0
    ds_read_b64_tr_b16 v[114:115], v179 offset:768
    v_mfma_f32_16x16x32_bf16 v[80:83], v[124:127], v[148:151], v[80:83]
    s_mul_i32 s70, s68, 88064
    s_mul_i32 s71, s68, 98304
    v_mfma_f32_32x32x16_bf16 v[32:47], v[124:127], v[100:103], v[32:47]
    s_add_u32 m0, s83, 0
    s_add_u32 s68, s68, 1
    buffer_load_dwordx4 v154, s[12:15], s70 offen lds
    s_add_u32 m0, s83, 6144
    v_mfma_f32_16x16x32_bf16 v[88:91], v[144:147], v[144:147], v[88:91]
    s_and_b32 s68, s68, 15
    v_mfma_f32_32x32x16_bf16 v[48:63], v[124:127], v[104:107], v[48:63]
    buffer_load_dwordx4 v155, s[20:23], s71 offen lds
    s_add_u32 m0, s83, 12320
    s_add_u32 s83, s83, 18496
    buffer_load_dwordx4 v154, s[16:19], s70 offen lds
    v_mfma_f32_16x16x32_bf16 v[64:67], v[140:143], v[132:135], v[64:67]
    s_cmp_ge_u32 s83, 55488
    s_cselect_b32 s83, s85, s83
    v_mfma_f32_16x16x32_bf16 v[68:71], v[136:139], v[132:135], v[68:71]
    s_waitcnt lgkmcnt(0)
    v_mfma_f32_32x32x16_bf16 v[0:15], v[108:111], v[92:95], v[0:15]
    ds_read_b128 v[100:103], v171
    ds_read_b64_tr_b16 v[120:121], v178 offset:3072
    ds_read_b64_tr_b16 v[122:123], v178 offset:3840
    ds_read_b128 v[104:107], v175
    ds_read_b64_tr_b16 v[124:125], v179 offset:3072
    ds_read_b64_tr_b16 v[126:127], v179 offset:3840
    ds_read_b128 v[144:147], v184
    ds_read_b128 v[132:135], v181
    v_mfma_f32_32x32x16_bf16 v[16:31], v[108:111], v[96:99], v[16:31]
    ds_read_b128 v[136:139], v182
    ds_read_b64_tr_b16 v[140:141], v183
    ds_read_b64_tr_b16 v[142:143], v183 offset:768
    s_lshl_b32 s72, s69, 7
    s_add_u32 m0, s84, 0
    s_add_u32 s69, s69, 1
    buffer_load_dwordx4 v156, s[8:11], s72 offen lds
    s_add_u32 m0, s84, 1024
    s_and_b32 s69, s69, 7
    v_mfma_f32_16x16x32_bf16 v[80:83], v[112:115], v[148:151], v[80:83]
    buffer_load_dwordx4 v157, s[8:11], s72 offen lds
    s_add_u32 m0, s84, 2048
    s_add_u32 s84, s84, 18432
    buffer_load_dwordx4 v158, s[8:11], s72 offen lds
    s_cmp_ge_u32 s84, 129408
    v_mfma_f32_32x32x16_bf16 v[32:47], v[112:115], v[92:95], v[32:47]
    s_cselect_b32 s84, s89, s84
    v_add_u32 v178, s66, v161
    v_add_u32 v179, s66, v162
    v_add_u32 v183, s66, v166
    v_add_u32 v181, s67, v165
    v_xor_b32 v181, 64, v181
    v_mad_u32_u24 v182, v167, v181, v168
    v_add_u32 v184, s67, v169
    v_xor_b32 v184, 64, v184
    v_mfma_f32_32x32x16_bf16 v[48:63], v[112:115], v[96:99], v[48:63]
    s_waitcnt vmcnt(6) lgkmcnt(0)
    s_barrier
    v_mfma_f32_32x32x16_bf16 v[0:15], v[120:123], v[100:103], v[0:15]
    ds_read_b128 v[92:95], v172
    ds_read_b64_tr_b16 v[108:109], v178 offset:0
    v_mfma_f32_32x32x16_bf16 v[16:31], v[120:123], v[104:107], v[16:31]
    ds_read_b64_tr_b16 v[110:111], v178 offset:768
    ds_read_b128 v[96:99], v176
    ds_read_b64_tr_b16 v[112:113], v179 offset:0
    v_mfma_f32_16x16x32_bf16 v[80:83], v[124:127], v[148:151], v[80:83]
    ds_read_b64_tr_b16 v[114:115], v179 offset:768
    v_mfma_f32_32x32x16_bf16 v[32:47], v[124:127], v[100:103], v[32:47]
    s_mul_i32 s70, s68, 88064
    s_mul_i32 s71, s68, 98304
    v_mfma_f32_16x16x32_bf16 v[88:91], v[144:147], v[144:147], v[88:91]
    s_add_u32 m0, s83, 0
    s_add_u32 s68, s68, 1
    v_mfma_f32_32x32x16_bf16 v[48:63], v[124:127], v[104:107], v[48:63]
    buffer_load_dwordx4 v154, s[12:15], s70 offen lds
    s_add_u32 m0, s83, 6144
    v_mfma_f32_16x16x32_bf16 v[64:67], v[140:143], v[132:135], v[64:67]
    s_and_b32 s68, s68, 15
    buffer_load_dwordx4 v155, s[20:23], s71 offen lds
    v_mfma_f32_16x16x32_bf16 v[68:71], v[136:139], v[132:135], v[68:71]
    s_waitcnt lgkmcnt(0)
    v_mfma_f32_32x32x16_bf16 v[0:15], v[108:111], v[92:95], v[0:15]
    ds_read_b128 v[100:103], v173
    ds_read_b64_tr_b16 v[120:121], v178 offset:3072
    ds_read_b64_tr_b16 v[122:123], v178 offset:3840
    ds_read_b128 v[104:107], v177
    ds_read_b64_tr_b16 v[124:125], v179 offset:3072
    ds_read_b64_tr_b16 v[126:127], v179 offset:3840
    ds_read_b128 v[144:147], v184
    ds_read_b128 v[132:135], v181
    ds_read_b128 v[136:139], v182
    ds_read_b64_tr_b16 v[140:141], v183
    ds_read_b64_tr_b16 v[142:143], v183 offset:768
    s_add_u32 m0, s83, 12320
    s_add_u32 s83, s83, 18496
    v_mfma_f32_32x32x16_bf16 v[16:31], v[108:111], v[96:99], v[16:31]
    buffer_load_dwordx4 v154, s[16:19], s70 offen lds
    s_cmp_ge_u32 s83, 55488
    s_cselect_b32 s83, s85, s83
    s_cmp_eq_u32 s73, 7
    s_cselect_b32 s10, 0, s10
    s_cselect_b32 s14, 0, s14
    s_cselect_b32 s18, 0, s18
    s_cselect_b32 s22, 0, s22
    s_add_u32 s65, s65, 36992
    s_sub_u32 s75, s65, 55488
    s_cmp_ge_u32 s65, 55488
    s_cselect_b32 s65, s75, s65
    s_add_u32 s66, s66, 36992
    v_mfma_f32_16x16x32_bf16 v[80:83], v[112:115], v[148:151], v[80:83]
    s_sub_u32 s75, s66, 55488
    s_cmp_ge_u32 s66, 55488
    s_cselect_b32 s66, s75, s66
    s_add_u32 s67, s67, 18432
    s_cmp_ge_u32 s67, 129408
    s_cselect_b32 s67, 92544, s67
    v_mfma_f32_32x32x16_bf16 v[32:47], v[112:115], v[92:95], v[32:47]
    v_add_u32 v170, s67, v159
    v_add_u32 v174, s67, v160
    v_xor_b32 v171, 32, v170
    v_xor_b32 v175, 32, v174
    v_xor_b32 v172, 64, v170
    v_xor_b32 v176, 64, v174
    v_xor_b32 v173, 96, v170
    v_xor_b32 v177, 96, v174
    v_add_u32 v178, s65, v161
    v_add_u32 v179, s65, v162
    v_add_u32 v183, s65, v166
    v_add_u32 v181, s67, v165
    v_mad_u32_u24 v182, v167, v181, v168
    v_add_u32 v184, s67, v169
    v_mfma_f32_32x32x16_bf16 v[48:63], v[112:115], v[96:99], v[48:63]
    s_add_u32 s73, s73, 1
    s_cmp_lt_u32 s73, 9
    s_cbranch_scc1 K1_LOOPH
    s_waitcnt lgkmcnt(0)
    v_mfma_f32_32x32x16_bf16 v[0:15], v[120:123], v[100:103], v[0:15]
    v_mfma_f32_32x32x16_bf16 v[16:31], v[120:123], v[104:107], v[16:31]
    v_mfma_f32_16x16x32_bf16 v[80:83], v[124:127], v[148:151], v[80:83]
    v_mfma_f32_32x32x16_bf16 v[32:47], v[124:127], v[100:103], v[32:47]
    v_mfma_f32_16x16x32_bf16 v[88:91], v[144:147], v[144:147], v[88:91]
    v_mfma_f32_32x32x16_bf16 v[48:63], v[124:127], v[104:107], v[48:63]
    v_mfma_f32_16x16x32_bf16 v[64:67], v[140:143], v[132:135], v[64:67]
    v_mfma_f32_16x16x32_bf16 v[68:71], v[136:139], v[132:135], v[68:71]
    v_and_b32 v186, 15, v152
    v_lshrrev_b32 v187, 4, v152
    v_lshlrev_b32 v188, 6, v186
    v_lshl_add_u32 v188, v187, 4, v188
    s_lshl_b32 s3, s53, 8
    s_add_u32 s3, s3, 160256
    v_add_u32 v189, s3, v188
    s_lshl_b32 s3, s53, 7
    s_add_u32 s3, s3, 161152
    v_add_u32 v190, s3, v188
    v_and_b32 v191, 3, v152
    v_lshlrev_b32 v192, 2, v152
    s_lshl_b32 s3, s52, 8
    s_add_u32 s3, s3, 148864
    v_add_u32 v193, s3, v192
    v_cmp_eq_u32 vcc, 1, v191
    v_cmp_eq_u32 s[86:87], 2, v191
    v_cmp_eq_u32 s[4:5], 3, v191
    v_cndmask_b32 v194, v88, v89, vcc
    v_cndmask_b32 v194, v194, v90, s[86:87]
    v_cndmask_b32 v194, v194, v91, s[4:5]
    ds_write_b32 v193, v194
    v_cmp_eq_u32 vcc, 1, v191
    v_cmp_eq_u32 s[86:87], 2, v191
    v_cmp_eq_u32 s[4:5], 3, v191
    v_cndmask_b32 v195, v68, v69, vcc
    v_cndmask_b32 v195, v195, v70, s[86:87]
    v_cndmask_b32 v195, v195, v71, s[4:5]
    s_lshl_b32 s3, s53, 9
    s_add_u32 s3, s3, 151936
    v_add_u32 v196, s3, v192
    ds_write_b32 v196, v195
    ds_write_b32 v196, v68 offset:256
    v_cmp_gt_u32 vcc, 2, v186
    s_and_saveexec_b64 s[4:5], vcc
    ds_write_b128 v189, v[80:83]
    s_mov_b64 exec, s[4:5]
    v_and_b32 v186, 31, v152
    v_lshlrev_b32 v186, 2, v186
    s_lshl_b32 s3, s79, 7
    s_lshl_b32 s4, s80, 7
    v_add_u32 v188, s3, v186
    v_add_u32 v189, s4, v186
    s_mov_b32 s77, 0
    s_waitcnt vmcnt(0)
    s_branch K1_EPI
K1_EPI:
    s_waitcnt lgkmcnt(0)
    s_barrier
    s_cmp_lg_u32 s52, 0
    s_cbranch_scc1 K1_FL1
    v_mov_b32 v199, 162176
    ds_read_b32 v198, v199
    s_waitcnt lgkmcnt(0)
    v_readfirstlane_b32 s100, v198
K1_FL1:
    v_lshlrev_b32 v254, 4, v152
    s_and_b32 s3, s2, 7
    s_lshr_b32 s4, s2, 3
    s_lshl_b32 s5, s3, 2
    s_and_b32 s6, s4, 3
    s_add_u32 s16, s5, s6
    s_lshr_b32 s17, s4, 2
    s_lshl_b32 s6, s17, 11
    v_add_u32 v254, s6, v254
    s_lshl_b32 s19, s52, 14
    s_mul_i32 s18, s52, 12288
    s_add_u32 s18, s18, 40960
    s_add_u32 m0, s18, 0
    s_nop 0
    buffer_load_dwordx4 v254, s[32:35], s19 offen sc1 lds
    s_add_u32 m0, s18, 1024
    s_add_u32 s19, s19, 1024
    buffer_load_dwordx4 v254, s[32:35], s19 offen sc1 lds
    s_add_u32 s19, s19, 130048
    s_add_u32 m0, s18, 2048
    s_nop 0
    buffer_load_dwordx4 v254, s[32:35], s19 offen sc1 lds
    s_add_u32 m0, s18, 3072
    s_add_u32 s19, s19, 1024
    buffer_load_dwordx4 v254, s[32:35], s19 offen sc1 lds
    s_add_u32 s19, s19, 130048
    v_add_u32 v190, 161664, v188
    v_add_u32 v191, 161664, v189
    ds_read_b32 v132, v190
    ds_read_b32 v133, v191
    v_and_b32 v192, 15, v152
    v_lshrrev_b32 v193, 2, v192
    v_lshl_add_u32 v192, v193, 4, v192
    v_lshlrev_b32 v192, 2, v192
    v_bfe_u32 v193, v152, 4, 1
    v_lshl_add_u32 v193, v193, 8, v192
    s_lshl_b32 s3, s79, 9
    s_add_u32 s3, s3, 148864
    s_lshl_b32 s4, s80, 9
    s_add_u32 s4, s4, 148864
    v_add_u32 v194, s3, v193
    v_add_u32 v193, s4, v193
    ds_read_b32 v134, v194
    ds_read_b32 v135, v193
    s_lshl_b32 s3, s53, 9
    s_add_u32 s3, s3, 151936
    v_add_u32 v192, s3, v192
    v_and_b32 v194, 15, v152
    v_lshlrev_b32 v194, 2, v194
    v_add_u32 v194, s3, v194
    ds_read_b32 v136, v194 offset:256
    ds_read_b32 v137, v192
    v_lshrrev_b32 v195, 5, v152
    v_lshlrev_b32 v196, 4, v195
    s_lshl_b32 s3, s53, 8
    s_add_u32 s3, s3, 160128
    v_add_u32 v197, s3, v196
    ds_read_b128 v[80:83], v197 offset:0
    ds_read_b128 v[84:87], v197 offset:32
    ds_read_b128 v[88:91], v197 offset:64
    ds_read_b128 v[92:95], v197 offset:96
    ds_read_b128 v[96:99], v197 offset:128
    ds_read_b128 v[100:103], v197 offset:160
    ds_read_b128 v[104:107], v197 offset:192
    ds_read_b128 v[108:111], v197 offset:224
    s_waitcnt lgkmcnt(8)
    s_cmp_eq_u32 s77, 1
    s_cbranch_scc0 K1_E_CH
    v_add_u32 v198, 161152, v196
    ds_read_b128 v[214:217], v198 offset:0
    ds_read_b128 v[218:221], v198 offset:32
    ds_read_b128 v[222:225], v198 offset:128
    ds_read_b128 v[226:229], v198 offset:160
    ds_read_b128 v[230:233], v198 offset:256
    ds_read_b128 v[234:237], v198 offset:288
    ds_read_b128 v[238:241], v198 offset:384
    ds_read_b128 v[242:245], v198 offset:416
    s_waitcnt lgkmcnt(0)
    v_add_f32 v112, v214, v222
    v_add_f32 v230, v230, v238
    v_add_f32 v113, v215, v223
    v_add_f32 v231, v231, v239
    v_add_f32 v114, v216, v224
    v_add_f32 v232, v232, v240
    v_add_f32 v115, v217, v225
    v_add_f32 v233, v233, v241
    v_add_f32 v116, v218, v226
    v_add_f32 v234, v234, v242
    v_add_f32 v117, v219, v227
    v_add_f32 v235, v235, v243
    v_add_f32 v118, v220, v228
    v_add_f32 v236, v236, v244
    v_add_f32 v119, v221, v229
    v_add_f32 v237, v237, v245
    v_add_f32 v112, v112, v230
    v_add_f32 v113, v113, v231
    v_add_f32 v114, v114, v232
    v_add_f32 v115, v115, v233
    v_add_f32 v116, v116, v234
    v_add_f32 v117, v117, v235
    v_add_f32 v118, v118, v236
    v_add_f32 v119, v119, v237
    s_branch K1_E_CD
K1_E_CH:
    v_lshrrev_b32 v199, 4, v152
    v_lshlrev_b32 v199, 4, v199
    s_lshl_b32 s3, s53, 6
    s_add_u32 s3, s3, 160256
    v_add_u32 v199, s3, v199
    ds_read_b128 v[112:115], v199
K1_E_CD:
    v_mul_f32 v206, 0x3b000000, v132
    v_mul_f32 v207, 0x3b000000, v134
    v_fma_f32 v207, -v206, v206, v207
    v_max_f32 v207, 0, v207
    v_cvt_pk_bf16_f32 v208, v206, v207
    v_lshlrev_b32 v206, 16, v208
    v_and_b32 v207, 0xffff0000, v208
    v_add_f32 v207, 0x3727c5ac, v207
    v_cvt_pk_bf16_f32 v208, v207, v207
    v_and_b32 v207, 0xffff0000, v208
    v_sqrt_f32 v207, v207
    v_xor_b32 v121, 0x80000000, v206
    v_cvt_pk_bf16_f32 v208, v207, v207
    v_and_b32 v207, 0xffff0000, v208
    v_rcp_f32 v120, v207
    v_mul_f32 v123, v207, v207
    v_mul_f32 v122, 0xbfb8aa3b, v120
    v_mul_f32 v206, 0x3b000000, v133
    v_mul_f32 v207, 0x3b000000, v135
    v_fma_f32 v207, -v206, v206, v207
    v_max_f32 v207, 0, v207
    v_cvt_pk_bf16_f32 v208, v206, v207
    v_lshlrev_b32 v206, 16, v208
    v_and_b32 v207, 0xffff0000, v208
    v_add_f32 v207, 0x3727c5ac, v207
    v_cvt_pk_bf16_f32 v208, v207, v207
    v_and_b32 v207, 0xffff0000, v208
    v_sqrt_f32 v207, v207
    v_xor_b32 v125, 0x80000000, v206
    v_cvt_pk_bf16_f32 v208, v207, v207
    v_and_b32 v207, 0xffff0000, v208
    v_rcp_f32 v124, v207
    v_mul_f32 v127, v207, v207
    v_mul_f32 v126, 0xbfb8aa3b, v124
    v_and_b32 v186, 31, v152
    v_mul_u32_u24 v186, 272, v186
    v_lshl_add_u32 v187, v195, 3, v186
    v_lshl_add_u32 v188, v195, 4, v186
    s_mul_i32 s3, s79, 8704
    s_add_u32 s3, s3, 4352
    s_mul_i32 s4, s80, 8704
    s_add_u32 s4, s4, 4352
    v_add_u32 v189, s3, v187
    v_add_u32 v190, s4, v187
    v_add_u32 v191, s3, v188
    v_add_u32 v192, s4, v188
    v_lshlrev_b32 v193, 4, v152
    s_lshl_b32 s5, s55, 2
    s_add_u32 s75, s5, s79
    s_add_u32 s76, s5, s80
    s_waitcnt lgkmcnt(0)
    s_lshl_b32 s6, s53, 1
    s_add_u32 s6, s6, s58
    s_add_u32 s6, s6, 29
    s_lshl_b32 s6, s6, 6
    s_add_u32 s7, s6, 64
    s_cmp_eq_u32 s77, 1
    s_cbranch_scc1 K1_E_T
    v_mul_f32 v206, 0x3b000000, v136
    v_mul_f32 v207, 0x3b000000, v137
    v_fma_f32 v207, -v206, v206, v207
    v_max_f32 v207, 0, v207
    v_cvt_pk_bf16_f32 v208, v206, v207
    v_lshlrev_b32 v206, 16, v208
    v_and_b32 v207, 0xffff0000, v208
    v_add_f32 v207, 0x3727c5ac, v207
    v_cvt_pk_bf16_f32 v208, v207, v207
    v_and_b32 v207, 0xffff0000, v208
    v_sqrt_f32 v207, v207
    v_xor_b32 v129, 0x80000000, v206
    v_cvt_pk_bf16_f32 v208, v207, v207
    v_and_b32 v207, 0xffff0000, v208
    v_rcp_f32 v128, v207
    v_mul_f32 v131, v207, v207
    v_mul_f32 v130, 0xbfb8aa3b, v128
    v_pk_fma_f32 v[246:247], v[112:113], v[128:129], v[64:65] op_sel:[0,1,0] op_sel_hi:[1,1,1]
    v_pk_fma_f32 v[248:249], v[114:115], v[128:129], v[66:67] op_sel:[0,1,0] op_sel_hi:[1,1,1]
    v_pk_mul_f32 v[246:247], v[246:247], v[128:129] op_sel:[0,0] op_sel_hi:[1,0]
    v_pk_mul_f32 v[248:249], v[248:249], v[128:129] op_sel:[0,0] op_sel_hi:[1,0]
    v_and_b32 v186, 15, v152
    v_mul_u32_u24 v186, 272, v186
    v_lshrrev_b32 v187, 4, v152
    s_cmp_lt_u32 s53, 2
    s_cbranch_scc0 K1_E_HV
    v_cvt_pk_bf16_f32 v250, v246, v247
    v_cvt_pk_bf16_f32 v251, v248, v249
    v_lshl_add_u32 v186, v187, 3, v186
    s_lshl_b32 s3, s53, 5
    s_add_u32 s3, s3, 64
    v_add_u32 v186, s3, v186
    ds_write_b64 v186, v[250:251]
    s_branch K1_E_T
K1_E_HV:
    v_lshl_add_u32 v186, v187, 4, v186
    s_lshl_b32 s3, s53, 6
    s_add_u32 s3, s3, 0
    v_add_u32 v186, s3, v186
    ds_write_b128 v186, v[246:249]
K1_E_T:
    s_add_u32 m0, s18, 4096
    s_nop 0
    buffer_load_dwordx4 v254, s[32:35], s19 offen sc1 lds
    s_add_u32 m0, s18, 5120
    s_add_u32 s19, s19, 1024
    buffer_load_dwordx4 v254, s[32:35], s19 offen sc1 lds
    s_add_u32 s19, s19, 130048
    s_add_u32 m0, s18, 6144
    s_nop 0
    buffer_load_dwordx4 v254, s[32:35], s19 offen sc1 lds
    s_add_u32 m0, s18, 7168
    s_add_u32 s19, s19, 1024
    buffer_load_dwordx4 v254, s[32:35], s19 offen sc1 lds
    s_add_u32 s19, s19, 130048
    s_cmp_eq_u32 s53, 0
    s_cbranch_scc1 K1_E_G0
    s_cmp_eq_u32 s53, 1
    s_cbranch_scc1 K1_E_G1
    v_pk_fma_f32 v[206:207], v[80:81], v[120:121], v[0:1] op_sel:[0,1,0] op_sel_hi:[1,1,1]
    v_pk_fma_f32 v[208:209], v[82:83], v[120:121], v[2:3] op_sel:[0,1,0] op_sel_hi:[1,1,1]
    v_pk_fma_f32 v[210:211], v[84:85], v[120:121], v[4:5] op_sel:[0,1,0] op_sel_hi:[1,1,1]
    v_pk_fma_f32 v[212:213], v[86:87], v[120:121], v[6:7] op_sel:[0,1,0] op_sel_hi:[1,1,1]
    v_pk_mul_f32 v[214:215], v[206:207], v[122:123] op_sel:[0,0] op_sel_hi:[1,0]
    v_pk_mul_f32 v[216:217], v[208:209], v[122:123] op_sel:[0,0] op_sel_hi:[1,0]
    v_pk_mul_f32 v[218:219], v[210:211], v[122:123] op_sel:[0,0] op_sel_hi:[1,0]
    v_pk_mul_f32 v[220:221], v[212:213], v[122:123] op_sel:[0,0] op_sel_hi:[1,0]
    v_exp_f32 v214, v214
    v_exp_f32 v215, v215
    v_exp_f32 v216, v216
    v_exp_f32 v217, v217
    v_exp_f32 v218, v218
    v_exp_f32 v219, v219
    v_exp_f32 v220, v220
    v_exp_f32 v221, v221
    v_pk_fma_f32 v[222:223], v[88:89], v[120:121], v[8:9] op_sel:[0,1,0] op_sel_hi:[1,1,1]
    v_pk_fma_f32 v[224:225], v[90:91], v[120:121], v[10:11] op_sel:[0,1,0] op_sel_hi:[1,1,1]
    v_pk_fma_f32 v[226:227], v[92:93], v[120:121], v[12:13] op_sel:[0,1,0] op_sel_hi:[1,1,1]
    v_pk_fma_f32 v[228:229], v[94:95], v[120:121], v[14:15] op_sel:[0,1,0] op_sel_hi:[1,1,1]
    v_pk_fma_f32 v[214:215], v[214:215], v[122:123], v[122:123] op_sel:[0,1,1] op_sel_hi:[1,1,1]
    v_pk_fma_f32 v[216:217], v[216:217], v[122:123], v[122:123] op_sel:[0,1,1] op_sel_hi:[1,1,1]
    v_pk_fma_f32 v[218:219], v[218:219], v[122:123], v[122:123] op_sel:[0,1,1] op_sel_hi:[1,1,1]
    v_pk_fma_f32 v[220:221], v[220:221], v[122:123], v[122:123] op_sel:[0,1,1] op_sel_hi:[1,1,1]
    v_rcp_f32 v214, v214
    v_rcp_f32 v215, v215
    v_rcp_f32 v216, v216
    v_rcp_f32 v217, v217
    v_rcp_f32 v218, v218
    v_rcp_f32 v219, v219
    v_rcp_f32 v220, v220
    v_rcp_f32 v221, v221
    v_pk_mul_f32 v[206:207], v[206:207], v[222:223] op_sel:[0,0] op_sel_hi:[1,1]
    v_pk_mul_f32 v[208:209], v[208:209], v[224:225] op_sel:[0,0] op_sel_hi:[1,1]
    v_pk_mul_f32 v[210:211], v[210:211], v[226:227] op_sel:[0,0] op_sel_hi:[1,1]
    v_pk_mul_f32 v[212:213], v[212:213], v[228:229] op_sel:[0,0] op_sel_hi:[1,1]
    v_pk_mul_f32 v[206:207], v[206:207], v[214:215] op_sel:[0,0] op_sel_hi:[1,1]
    v_pk_mul_f32 v[208:209], v[208:209], v[216:217] op_sel:[0,0] op_sel_hi:[1,1]
    v_pk_mul_f32 v[210:211], v[210:211], v[218:219] op_sel:[0,0] op_sel_hi:[1,1]
    v_pk_mul_f32 v[212:213], v[212:213], v[220:221] op_sel:[0,0] op_sel_hi:[1,1]
    v_cvt_pk_bf16_f32 v230, v206, v207
    v_cvt_pk_bf16_f32 v231, v208, v209
    v_cvt_pk_bf16_f32 v232, v210, v211
    v_cvt_pk_bf16_f32 v233, v212, v213
    s_add_u32 s3, s6, s75
    s_lshl_b32 s3, s3, 10
    buffer_store_dwordx4 v[230:233], v193, s[28:31], s3 offen sc1
    s_waitcnt lgkmcnt(0)
    s_barrier
    v_pk_fma_f32 v[152:153], v[80:81], v[124:125], v[16:17] op_sel:[0,1,0] op_sel_hi:[1,1,1]
    v_pk_fma_f32 v[154:155], v[82:83], v[124:125], v[18:19] op_sel:[0,1,0] op_sel_hi:[1,1,1]
    v_pk_fma_f32 v[156:157], v[84:85], v[124:125], v[20:21] op_sel:[0,1,0] op_sel_hi:[1,1,1]
    v_pk_fma_f32 v[158:159], v[86:87], v[124:125], v[22:23] op_sel:[0,1,0] op_sel_hi:[1,1,1]
    v_pk_mul_f32 v[160:161], v[152:153], v[126:127] op_sel:[0,0] op_sel_hi:[1,0]
    v_pk_mul_f32 v[162:163], v[154:155], v[126:127] op_sel:[0,0] op_sel_hi:[1,0]
    v_pk_mul_f32 v[164:165], v[156:157], v[126:127] op_sel:[0,0] op_sel_hi:[1,0]
    v_pk_mul_f32 v[166:167], v[158:159], v[126:127] op_sel:[0,0] op_sel_hi:[1,0]
    v_exp_f32 v160, v160
    v_exp_f32 v161, v161
    v_exp_f32 v162, v162
    v_exp_f32 v163, v163
    v_exp_f32 v164, v164
    v_exp_f32 v165, v165
    v_exp_f32 v166, v166
    v_exp_f32 v167, v167
    v_pk_fma_f32 v[168:169], v[88:89], v[124:125], v[24:25] op_sel:[0,1,0] op_sel_hi:[1,1,1]
    v_pk_fma_f32 v[170:171], v[90:91], v[124:125], v[26:27] op_sel:[0,1,0] op_sel_hi:[1,1,1]
    v_pk_fma_f32 v[172:173], v[92:93], v[124:125], v[28:29] op_sel:[0,1,0] op_sel_hi:[1,1,1]
    v_pk_fma_f32 v[174:175], v[94:95], v[124:125], v[30:31] op_sel:[0,1,0] op_sel_hi:[1,1,1]
    v_pk_fma_f32 v[160:161], v[160:161], v[126:127], v[126:127] op_sel:[0,1,1] op_sel_hi:[1,1,1]
    v_pk_fma_f32 v[162:163], v[162:163], v[126:127], v[126:127] op_sel:[0,1,1] op_sel_hi:[1,1,1]
    v_pk_fma_f32 v[164:165], v[164:165], v[126:127], v[126:127] op_sel:[0,1,1] op_sel_hi:[1,1,1]
    v_pk_fma_f32 v[166:167], v[166:167], v[126:127], v[126:127] op_sel:[0,1,1] op_sel_hi:[1,1,1]
    v_rcp_f32 v160, v160
    v_rcp_f32 v161, v161
    v_rcp_f32 v162, v162
    v_rcp_f32 v163, v163
    v_rcp_f32 v164, v164
    v_rcp_f32 v165, v165
    v_rcp_f32 v166, v166
    v_rcp_f32 v167, v167
    v_pk_mul_f32 v[152:153], v[152:153], v[168:169] op_sel:[0,0] op_sel_hi:[1,1]
    v_pk_mul_f32 v[154:155], v[154:155], v[170:171] op_sel:[0,0] op_sel_hi:[1,1]
    v_pk_mul_f32 v[156:157], v[156:157], v[172:173] op_sel:[0,0] op_sel_hi:[1,1]
    v_pk_mul_f32 v[158:159], v[158:159], v[174:175] op_sel:[0,0] op_sel_hi:[1,1]
    v_pk_mul_f32 v[152:153], v[152:153], v[160:161] op_sel:[0,0] op_sel_hi:[1,1]
    v_pk_mul_f32 v[154:155], v[154:155], v[162:163] op_sel:[0,0] op_sel_hi:[1,1]
    v_pk_mul_f32 v[156:157], v[156:157], v[164:165] op_sel:[0,0] op_sel_hi:[1,1]
    v_pk_mul_f32 v[158:159], v[158:159], v[166:167] op_sel:[0,0] op_sel_hi:[1,1]
    v_cvt_pk_bf16_f32 v176, v152, v153
    v_cvt_pk_bf16_f32 v177, v154, v155
    v_cvt_pk_bf16_f32 v178, v156, v157
    v_cvt_pk_bf16_f32 v179, v158, v159
    s_add_u32 s3, s6, s76
    s_lshl_b32 s3, s3, 10
    buffer_store_dwordx4 v[176:179], v193, s[28:31], s3 offen sc1
    s_branch K1_E_B
K1_E_G0:
    v_pk_fma_f32 v[206:207], v[80:81], v[120:121], v[0:1] op_sel:[0,1,0] op_sel_hi:[1,1,1]
    v_pk_fma_f32 v[208:209], v[82:83], v[120:121], v[2:3] op_sel:[0,1,0] op_sel_hi:[1,1,1]
    v_pk_fma_f32 v[210:211], v[84:85], v[120:121], v[4:5] op_sel:[0,1,0] op_sel_hi:[1,1,1]
    v_pk_fma_f32 v[212:213], v[86:87], v[120:121], v[6:7] op_sel:[0,1,0] op_sel_hi:[1,1,1]
    v_pk_fma_f32 v[214:215], v[88:89], v[120:121], v[8:9] op_sel:[0,1,0] op_sel_hi:[1,1,1]
    v_pk_fma_f32 v[216:217], v[90:91], v[120:121], v[10:11] op_sel:[0,1,0] op_sel_hi:[1,1,1]
    v_pk_fma_f32 v[218:219], v[92:93], v[120:121], v[12:13] op_sel:[0,1,0] op_sel_hi:[1,1,1]
    v_pk_fma_f32 v[220:221], v[94:95], v[120:121], v[14:15] op_sel:[0,1,0] op_sel_hi:[1,1,1]
    v_pk_mul_f32 v[206:207], v[206:207], v[120:121] op_sel:[0,0] op_sel_hi:[1,0]
    v_pk_mul_f32 v[208:209], v[208:209], v[120:121] op_sel:[0,0] op_sel_hi:[1,0]
    v_pk_mul_f32 v[210:211], v[210:211], v[120:121] op_sel:[0,0] op_sel_hi:[1,0]
    v_pk_mul_f32 v[212:213], v[212:213], v[120:121] op_sel:[0,0] op_sel_hi:[1,0]
    v_pk_mul_f32 v[214:215], v[214:215], v[120:121] op_sel:[0,0] op_sel_hi:[1,0]
    v_pk_mul_f32 v[216:217], v[216:217], v[120:121] op_sel:[0,0] op_sel_hi:[1,0]
    v_pk_mul_f32 v[218:219], v[218:219], v[120:121] op_sel:[0,0] op_sel_hi:[1,0]
    v_pk_mul_f32 v[220:221], v[220:221], v[120:121] op_sel:[0,0] op_sel_hi:[1,0]
    v_cvt_pk_bf16_f32 v222, v206, v207
    v_cvt_pk_bf16_f32 v223, v208, v209
    v_cvt_pk_bf16_f32 v224, v210, v211
    v_cvt_pk_bf16_f32 v225, v212, v213
    v_cvt_pk_bf16_f32 v226, v214, v215
    v_cvt_pk_bf16_f32 v227, v216, v217
    v_cvt_pk_bf16_f32 v228, v218, v219
    v_cvt_pk_bf16_f32 v229, v220, v221
    ds_write_b64 v189, v[222:223] offset:0
    ds_write_b64 v189, v[224:225] offset:16
    ds_write_b64 v189, v[226:227] offset:32
    ds_write_b64 v189, v[228:229] offset:48
    v_pk_fma_f32 v[206:207], v[80:81], v[124:125], v[16:17] op_sel:[0,1,0] op_sel_hi:[1,1,1]
    v_pk_fma_f32 v[208:209], v[82:83], v[124:125], v[18:19] op_sel:[0,1,0] op_sel_hi:[1,1,1]
    v_pk_fma_f32 v[210:211], v[84:85], v[124:125], v[20:21] op_sel:[0,1,0] op_sel_hi:[1,1,1]
    v_pk_fma_f32 v[212:213], v[86:87], v[124:125], v[22:23] op_sel:[0,1,0] op_sel_hi:[1,1,1]
    v_pk_fma_f32 v[214:215], v[88:89], v[124:125], v[24:25] op_sel:[0,1,0] op_sel_hi:[1,1,1]
    v_pk_fma_f32 v[216:217], v[90:91], v[124:125], v[26:27] op_sel:[0,1,0] op_sel_hi:[1,1,1]
    v_pk_fma_f32 v[218:219], v[92:93], v[124:125], v[28:29] op_sel:[0,1,0] op_sel_hi:[1,1,1]
    v_pk_fma_f32 v[220:221], v[94:95], v[124:125], v[30:31] op_sel:[0,1,0] op_sel_hi:[1,1,1]
    v_pk_mul_f32 v[206:207], v[206:207], v[124:125] op_sel:[0,0] op_sel_hi:[1,0]
    v_pk_mul_f32 v[208:209], v[208:209], v[124:125] op_sel:[0,0] op_sel_hi:[1,0]
    v_pk_mul_f32 v[210:211], v[210:211], v[124:125] op_sel:[0,0] op_sel_hi:[1,0]
    v_pk_mul_f32 v[212:213], v[212:213], v[124:125] op_sel:[0,0] op_sel_hi:[1,0]
    v_pk_mul_f32 v[214:215], v[214:215], v[124:125] op_sel:[0,0] op_sel_hi:[1,0]
    v_pk_mul_f32 v[216:217], v[216:217], v[124:125] op_sel:[0,0] op_sel_hi:[1,0]
    v_pk_mul_f32 v[218:219], v[218:219], v[124:125] op_sel:[0,0] op_sel_hi:[1,0]
    v_pk_mul_f32 v[220:221], v[220:221], v[124:125] op_sel:[0,0] op_sel_hi:[1,0]
    v_cvt_pk_bf16_f32 v222, v206, v207
    v_cvt_pk_bf16_f32 v223, v208, v209
    v_cvt_pk_bf16_f32 v224, v210, v211
    v_cvt_pk_bf16_f32 v225, v212, v213
    v_cvt_pk_bf16_f32 v226, v214, v215
    v_cvt_pk_bf16_f32 v227, v216, v217
    v_cvt_pk_bf16_f32 v228, v218, v219
    v_cvt_pk_bf16_f32 v229, v220, v221
    ds_write_b64 v190, v[222:223] offset:0
    ds_write_b64 v190, v[224:225] offset:16
    ds_write_b64 v190, v[226:227] offset:32
    ds_write_b64 v190, v[228:229] offset:48
    v_pk_fma_f32 v[206:207], v[96:97], v[120:121], v[32:33] op_sel:[0,1,0] op_sel_hi:[1,1,1]
    v_pk_fma_f32 v[208:209], v[98:99], v[120:121], v[34:35] op_sel:[0,1,0] op_sel_hi:[1,1,1]
    v_pk_fma_f32 v[210:211], v[100:101], v[120:121], v[36:37] op_sel:[0,1,0] op_sel_hi:[1,1,1]
    v_pk_fma_f32 v[212:213], v[102:103], v[120:121], v[38:39] op_sel:[0,1,0] op_sel_hi:[1,1,1]
    v_pk_fma_f32 v[214:215], v[104:105], v[120:121], v[40:41] op_sel:[0,1,0] op_sel_hi:[1,1,1]
    v_pk_fma_f32 v[216:217], v[106:107], v[120:121], v[42:43] op_sel:[0,1,0] op_sel_hi:[1,1,1]
    v_pk_fma_f32 v[218:219], v[108:109], v[120:121], v[44:45] op_sel:[0,1,0] op_sel_hi:[1,1,1]
    v_pk_fma_f32 v[220:221], v[110:111], v[120:121], v[46:47] op_sel:[0,1,0] op_sel_hi:[1,1,1]
    v_pk_mul_f32 v[206:207], v[206:207], v[120:121] op_sel:[0,0] op_sel_hi:[1,0]
    v_pk_mul_f32 v[208:209], v[208:209], v[120:121] op_sel:[0,0] op_sel_hi:[1,0]
    v_pk_mul_f32 v[210:211], v[210:211], v[120:121] op_sel:[0,0] op_sel_hi:[1,0]
    v_pk_mul_f32 v[212:213], v[212:213], v[120:121] op_sel:[0,0] op_sel_hi:[1,0]
    v_pk_mul_f32 v[214:215], v[214:215], v[120:121] op_sel:[0,0] op_sel_hi:[1,0]
    v_pk_mul_f32 v[216:217], v[216:217], v[120:121] op_sel:[0,0] op_sel_hi:[1,0]
    v_pk_mul_f32 v[218:219], v[218:219], v[120:121] op_sel:[0,0] op_sel_hi:[1,0]
    v_pk_mul_f32 v[220:221], v[220:221], v[120:121] op_sel:[0,0] op_sel_hi:[1,0]
    v_cvt_pk_bf16_f32 v222, v206, v207
    v_cvt_pk_bf16_f32 v223, v208, v209
    v_cvt_pk_bf16_f32 v224, v210, v211
    v_cvt_pk_bf16_f32 v225, v212, v213
    v_cvt_pk_bf16_f32 v226, v214, v215
    v_cvt_pk_bf16_f32 v227, v216, v217
    v_cvt_pk_bf16_f32 v228, v218, v219
    v_cvt_pk_bf16_f32 v229, v220, v221
    ds_write_b64 v189, v[222:223] offset:64
    ds_write_b64 v189, v[224:225] offset:80
    ds_write_b64 v189, v[226:227] offset:96
    ds_write_b64 v189, v[228:229] offset:112
    v_pk_fma_f32 v[206:207], v[96:97], v[124:125], v[48:49] op_sel:[0,1,0] op_sel_hi:[1,1,1]
    v_pk_fma_f32 v[208:209], v[98:99], v[124:125], v[50:51] op_sel:[0,1,0] op_sel_hi:[1,1,1]
    v_pk_fma_f32 v[210:211], v[100:101], v[124:125], v[52:53] op_sel:[0,1,0] op_sel_hi:[1,1,1]
    v_pk_fma_f32 v[212:213], v[102:103], v[124:125], v[54:55] op_sel:[0,1,0] op_sel_hi:[1,1,1]
    v_pk_fma_f32 v[214:215], v[104:105], v[124:125], v[56:57] op_sel:[0,1,0] op_sel_hi:[1,1,1]
    v_pk_fma_f32 v[216:217], v[106:107], v[124:125], v[58:59] op_sel:[0,1,0] op_sel_hi:[1,1,1]
    v_pk_fma_f32 v[218:219], v[108:109], v[124:125], v[60:61] op_sel:[0,1,0] op_sel_hi:[1,1,1]
    v_pk_fma_f32 v[220:221], v[110:111], v[124:125], v[62:63] op_sel:[0,1,0] op_sel_hi:[1,1,1]
    v_pk_mul_f32 v[206:207], v[206:207], v[124:125] op_sel:[0,0] op_sel_hi:[1,0]
    v_pk_mul_f32 v[208:209], v[208:209], v[124:125] op_sel:[0,0] op_sel_hi:[1,0]
    v_pk_mul_f32 v[210:211], v[210:211], v[124:125] op_sel:[0,0] op_sel_hi:[1,0]
    v_pk_mul_f32 v[212:213], v[212:213], v[124:125] op_sel:[0,0] op_sel_hi:[1,0]
    v_pk_mul_f32 v[214:215], v[214:215], v[124:125] op_sel:[0,0] op_sel_hi:[1,0]
    v_pk_mul_f32 v[216:217], v[216:217], v[124:125] op_sel:[0,0] op_sel_hi:[1,0]
    v_pk_mul_f32 v[218:219], v[218:219], v[124:125] op_sel:[0,0] op_sel_hi:[1,0]
    v_pk_mul_f32 v[220:221], v[220:221], v[124:125] op_sel:[0,0] op_sel_hi:[1,0]
    v_cvt_pk_bf16_f32 v222, v206, v207
    v_cvt_pk_bf16_f32 v223, v208, v209
    v_cvt_pk_bf16_f32 v224, v210, v211
    v_cvt_pk_bf16_f32 v225, v212, v213
    v_cvt_pk_bf16_f32 v226, v214, v215
    v_cvt_pk_bf16_f32 v227, v216, v217
    v_cvt_pk_bf16_f32 v228, v218, v219
    v_cvt_pk_bf16_f32 v229, v220, v221
    ds_write_b64 v190, v[222:223] offset:64
    ds_write_b64 v190, v[224:225] offset:80
    ds_write_b64 v190, v[226:227] offset:96
    ds_write_b64 v190, v[228:229] offset:112
    s_waitcnt lgkmcnt(0)
    s_barrier
    s_branch K1_E_C
K1_E_G1:
    v_pk_fma_f32 v[230:231], v[80:81], v[120:121], v[0:1] op_sel:[0,1,0] op_sel_hi:[1,1,1]
    v_pk_fma_f32 v[232:233], v[82:83], v[120:121], v[2:3] op_sel:[0,1,0] op_sel_hi:[1,1,1]
    v_pk_fma_f32 v[234:235], v[84:85], v[120:121], v[4:5] op_sel:[0,1,0] op_sel_hi:[1,1,1]
    v_pk_fma_f32 v[236:237], v[86:87], v[120:121], v[6:7] op_sel:[0,1,0] op_sel_hi:[1,1,1]
    v_pk_fma_f32 v[238:239], v[88:89], v[120:121], v[8:9] op_sel:[0,1,0] op_sel_hi:[1,1,1]
    v_pk_fma_f32 v[240:241], v[90:91], v[120:121], v[10:11] op_sel:[0,1,0] op_sel_hi:[1,1,1]
    v_pk_fma_f32 v[242:243], v[92:93], v[120:121], v[12:13] op_sel:[0,1,0] op_sel_hi:[1,1,1]
    v_pk_fma_f32 v[244:245], v[94:95], v[120:121], v[14:15] op_sel:[0,1,0] op_sel_hi:[1,1,1]
    v_pk_mul_f32 v[230:231], v[230:231], v[120:121] op_sel:[0,0] op_sel_hi:[1,0]
    v_pk_mul_f32 v[232:233], v[232:233], v[120:121] op_sel:[0,0] op_sel_hi:[1,0]
    v_pk_mul_f32 v[234:235], v[234:235], v[120:121] op_sel:[0,0] op_sel_hi:[1,0]
    v_pk_mul_f32 v[236:237], v[236:237], v[120:121] op_sel:[0,0] op_sel_hi:[1,0]
    v_pk_mul_f32 v[238:239], v[238:239], v[120:121] op_sel:[0,0] op_sel_hi:[1,0]
    v_pk_mul_f32 v[240:241], v[240:241], v[120:121] op_sel:[0,0] op_sel_hi:[1,0]
    v_pk_mul_f32 v[242:243], v[242:243], v[120:121] op_sel:[0,0] op_sel_hi:[1,0]
    v_pk_mul_f32 v[244:245], v[244:245], v[120:121] op_sel:[0,0] op_sel_hi:[1,0]
    ds_write_b128 v191, v[230:233] offset:128
    ds_write_b128 v191, v[234:237] offset:160
    ds_write_b128 v191, v[238:241] offset:192
    ds_write_b128 v191, v[242:245] offset:224
    s_nop 1
    v_pk_fma_f32 v[230:231], v[80:81], v[124:125], v[16:17] op_sel:[0,1,0] op_sel_hi:[1,1,1]
    v_pk_fma_f32 v[232:233], v[82:83], v[124:125], v[18:19] op_sel:[0,1,0] op_sel_hi:[1,1,1]
    v_pk_fma_f32 v[234:235], v[84:85], v[124:125], v[20:21] op_sel:[0,1,0] op_sel_hi:[1,1,1]
    v_pk_fma_f32 v[236:237], v[86:87], v[124:125], v[22:23] op_sel:[0,1,0] op_sel_hi:[1,1,1]
    v_pk_fma_f32 v[238:239], v[88:89], v[124:125], v[24:25] op_sel:[0,1,0] op_sel_hi:[1,1,1]
    v_pk_fma_f32 v[240:241], v[90:91], v[124:125], v[26:27] op_sel:[0,1,0] op_sel_hi:[1,1,1]
    v_pk_fma_f32 v[242:243], v[92:93], v[124:125], v[28:29] op_sel:[0,1,0] op_sel_hi:[1,1,1]
    v_pk_fma_f32 v[244:245], v[94:95], v[124:125], v[30:31] op_sel:[0,1,0] op_sel_hi:[1,1,1]
    v_pk_mul_f32 v[230:231], v[230:231], v[124:125] op_sel:[0,0] op_sel_hi:[1,0]
    v_pk_mul_f32 v[232:233], v[232:233], v[124:125] op_sel:[0,0] op_sel_hi:[1,0]
    v_pk_mul_f32 v[234:235], v[234:235], v[124:125] op_sel:[0,0] op_sel_hi:[1,0]
    v_pk_mul_f32 v[236:237], v[236:237], v[124:125] op_sel:[0,0] op_sel_hi:[1,0]
    v_pk_mul_f32 v[238:239], v[238:239], v[124:125] op_sel:[0,0] op_sel_hi:[1,0]
    v_pk_mul_f32 v[240:241], v[240:241], v[124:125] op_sel:[0,0] op_sel_hi:[1,0]
    v_pk_mul_f32 v[242:243], v[242:243], v[124:125] op_sel:[0,0] op_sel_hi:[1,0]
    v_pk_mul_f32 v[244:245], v[244:245], v[124:125] op_sel:[0,0] op_sel_hi:[1,0]
    ds_write_b128 v192, v[230:233] offset:128
    ds_write_b128 v192, v[234:237] offset:160
    ds_write_b128 v192, v[238:241] offset:192
    ds_write_b128 v192, v[242:245] offset:224
    s_waitcnt lgkmcnt(0)
    s_barrier
K1_E_B:
    v_pk_fma_f32 v[206:207], v[96:97], v[120:121], v[32:33] op_sel:[0,1,0] op_sel_hi:[1,1,1]
    v_pk_fma_f32 v[208:209], v[98:99], v[120:121], v[34:35] op_sel:[0,1,0] op_sel_hi:[1,1,1]
    v_pk_fma_f32 v[210:211], v[100:101], v[120:121], v[36:37] op_sel:[0,1,0] op_sel_hi:[1,1,1]
    v_pk_fma_f32 v[212:213], v[102:103], v[120:121], v[38:39] op_sel:[0,1,0] op_sel_hi:[1,1,1]
    v_pk_mul_f32 v[214:215], v[206:207], v[122:123] op_sel:[0,0] op_sel_hi:[1,0]
    v_pk_mul_f32 v[216:217], v[208:209], v[122:123] op_sel:[0,0] op_sel_hi:[1,0]
    v_pk_mul_f32 v[218:219], v[210:211], v[122:123] op_sel:[0,0] op_sel_hi:[1,0]
    v_pk_mul_f32 v[220:221], v[212:213], v[122:123] op_sel:[0,0] op_sel_hi:[1,0]
    v_exp_f32 v214, v214
    v_exp_f32 v215, v215
    v_exp_f32 v216, v216
    v_exp_f32 v217, v217
    v_exp_f32 v218, v218
    v_exp_f32 v219, v219
    v_exp_f32 v220, v220
    v_exp_f32 v221, v221
    v_pk_fma_f32 v[222:223], v[104:105], v[120:121], v[40:41] op_sel:[0,1,0] op_sel_hi:[1,1,1]
    v_pk_fma_f32 v[224:225], v[106:107], v[120:121], v[42:43] op_sel:[0,1,0] op_sel_hi:[1,1,1]
    v_pk_fma_f32 v[226:227], v[108:109], v[120:121], v[44:45] op_sel:[0,1,0] op_sel_hi:[1,1,1]
    v_pk_fma_f32 v[228:229], v[110:111], v[120:121], v[46:47] op_sel:[0,1,0] op_sel_hi:[1,1,1]
    v_pk_fma_f32 v[214:215], v[214:215], v[122:123], v[122:123] op_sel:[0,1,1] op_sel_hi:[1,1,1]
    v_pk_fma_f32 v[216:217], v[216:217], v[122:123], v[122:123] op_sel:[0,1,1] op_sel_hi:[1,1,1]
    v_pk_fma_f32 v[218:219], v[218:219], v[122:123], v[122:123] op_sel:[0,1,1] op_sel_hi:[1,1,1]
    v_pk_fma_f32 v[220:221], v[220:221], v[122:123], v[122:123] op_sel:[0,1,1] op_sel_hi:[1,1,1]
    v_rcp_f32 v214, v214
    v_rcp_f32 v215, v215
    v_rcp_f32 v216, v216
    v_rcp_f32 v217, v217
    v_rcp_f32 v218, v218
    v_rcp_f32 v219, v219
    v_rcp_f32 v220, v220
    v_rcp_f32 v221, v221
    v_pk_mul_f32 v[206:207], v[206:207], v[222:223] op_sel:[0,0] op_sel_hi:[1,1]
    v_pk_mul_f32 v[208:209], v[208:209], v[224:225] op_sel:[0,0] op_sel_hi:[1,1]
    v_pk_mul_f32 v[210:211], v[210:211], v[226:227] op_sel:[0,0] op_sel_hi:[1,1]
    v_pk_mul_f32 v[212:213], v[212:213], v[228:229] op_sel:[0,0] op_sel_hi:[1,1]
    v_pk_mul_f32 v[206:207], v[206:207], v[214:215] op_sel:[0,0] op_sel_hi:[1,1]
    v_pk_mul_f32 v[208:209], v[208:209], v[216:217] op_sel:[0,0] op_sel_hi:[1,1]
    v_pk_mul_f32 v[210:211], v[210:211], v[218:219] op_sel:[0,0] op_sel_hi:[1,1]
    v_pk_mul_f32 v[212:213], v[212:213], v[220:221] op_sel:[0,0] op_sel_hi:[1,1]
    v_cvt_pk_bf16_f32 v230, v206, v207
    v_cvt_pk_bf16_f32 v231, v208, v209
    v_cvt_pk_bf16_f32 v232, v210, v211
    v_cvt_pk_bf16_f32 v233, v212, v213
    s_add_u32 s3, s7, s75
    s_lshl_b32 s3, s3, 10
    buffer_store_dwordx4 v[230:233], v193, s[28:31], s3 offen sc1
    v_pk_fma_f32 v[152:153], v[96:97], v[124:125], v[48:49] op_sel:[0,1,0] op_sel_hi:[1,1,1]
    v_pk_fma_f32 v[154:155], v[98:99], v[124:125], v[50:51] op_sel:[0,1,0] op_sel_hi:[1,1,1]
    v_pk_fma_f32 v[156:157], v[100:101], v[124:125], v[52:53] op_sel:[0,1,0] op_sel_hi:[1,1,1]
    v_pk_fma_f32 v[158:159], v[102:103], v[124:125], v[54:55] op_sel:[0,1,0] op_sel_hi:[1,1,1]
    v_pk_mul_f32 v[160:161], v[152:153], v[126:127] op_sel:[0,0] op_sel_hi:[1,0]
    v_pk_mul_f32 v[162:163], v[154:155], v[126:127] op_sel:[0,0] op_sel_hi:[1,0]
    v_pk_mul_f32 v[164:165], v[156:157], v[126:127] op_sel:[0,0] op_sel_hi:[1,0]
    v_pk_mul_f32 v[166:167], v[158:159], v[126:127] op_sel:[0,0] op_sel_hi:[1,0]
    v_exp_f32 v160, v160
    v_exp_f32 v161, v161
    v_exp_f32 v162, v162
    v_exp_f32 v163, v163
    v_exp_f32 v164, v164
    v_exp_f32 v165, v165
    v_exp_f32 v166, v166
    v_exp_f32 v167, v167
    v_pk_fma_f32 v[168:169], v[104:105], v[124:125], v[56:57] op_sel:[0,1,0] op_sel_hi:[1,1,1]
    v_pk_fma_f32 v[170:171], v[106:107], v[124:125], v[58:59] op_sel:[0,1,0] op_sel_hi:[1,1,1]
    v_pk_fma_f32 v[172:173], v[108:109], v[124:125], v[60:61] op_sel:[0,1,0] op_sel_hi:[1,1,1]
    v_pk_fma_f32 v[174:175], v[110:111], v[124:125], v[62:63] op_sel:[0,1,0] op_sel_hi:[1,1,1]
    v_pk_fma_f32 v[160:161], v[160:161], v[126:127], v[126:127] op_sel:[0,1,1] op_sel_hi:[1,1,1]
    v_pk_fma_f32 v[162:163], v[162:163], v[126:127], v[126:127] op_sel:[0,1,1] op_sel_hi:[1,1,1]
    v_pk_fma_f32 v[164:165], v[164:165], v[126:127], v[126:127] op_sel:[0,1,1] op_sel_hi:[1,1,1]
    v_pk_fma_f32 v[166:167], v[166:167], v[126:127], v[126:127] op_sel:[0,1,1] op_sel_hi:[1,1,1]
    v_rcp_f32 v160, v160
    v_rcp_f32 v161, v161
    v_rcp_f32 v162, v162
    v_rcp_f32 v163, v163
    v_rcp_f32 v164, v164
    v_rcp_f32 v165, v165
    v_rcp_f32 v166, v166
    v_rcp_f32 v167, v167
    v_pk_mul_f32 v[152:153], v[152:153], v[168:169] op_sel:[0,0] op_sel_hi:[1,1]
    v_pk_mul_f32 v[154:155], v[154:155], v[170:171] op_sel:[0,0] op_sel_hi:[1,1]
    v_pk_mul_f32 v[156:157], v[156:157], v[172:173] op_sel:[0,0] op_sel_hi:[1,1]
    v_pk_mul_f32 v[158:159], v[158:159], v[174:175] op_sel:[0,0] op_sel_hi:[1,1]
    v_pk_mul_f32 v[152:153], v[152:153], v[160:161] op_sel:[0,0] op_sel_hi:[1,1]
    v_pk_mul_f32 v[154:155], v[154:155], v[162:163] op_sel:[0,0] op_sel_hi:[1,1]
    v_pk_mul_f32 v[156:157], v[156:157], v[164:165] op_sel:[0,0] op_sel_hi:[1,1]
    v_pk_mul_f32 v[158:159], v[158:159], v[166:167] op_sel:[0,0] op_sel_hi:[1,1]
    v_cvt_pk_bf16_f32 v176, v152, v153
    v_cvt_pk_bf16_f32 v177, v154, v155
    v_cvt_pk_bf16_f32 v178, v156, v157
    v_cvt_pk_bf16_f32 v179, v158, v159
    s_add_u32 s3, s7, s76
    s_lshl_b32 s3, s3, 10
    buffer_store_dwordx4 v[176:179], v193, s[28:31], s3 offen sc1
K1_E_C:
    s_add_u32 m0, s18, 8192
    s_nop 0
    buffer_load_dwordx4 v254, s[32:35], s19 offen sc1 lds
    s_add_u32 m0, s18, 9216
    s_add_u32 s19, s19, 1024
    buffer_load_dwordx4 v254, s[32:35], s19 offen sc1 lds
    s_add_u32 s19, s19, 130048
    s_add_u32 m0, s18, 10240
    s_nop 0
    buffer_load_dwordx4 v254, s[32:35], s19 offen sc1 lds
    s_add_u32 m0, s18, 11264
    s_add_u32 s19, s19, 1024
    buffer_load_dwordx4 v254, s[32:35], s19 offen sc1 lds
    s_add_u32 s19, s19, 130048
    s_and_b32 s3, s77, s64
    s_cbranch_scc0 K1_E_D
    v_pk_fma_f32 v[238:239], v[112:113], v[120:121], v[64:65] op_sel:[0,1,0] op_sel_hi:[1,1,1]
    v_pk_fma_f32 v[240:241], v[114:115], v[120:121], v[66:67] op_sel:[0,1,0] op_sel_hi:[1,1,1]
    v_pk_mul_f32 v[242:243], v[238:239], v[122:123] op_sel:[0,0] op_sel_hi:[1,0]
    v_pk_mul_f32 v[244:245], v[240:241], v[122:123] op_sel:[0,0] op_sel_hi:[1,0]
    v_exp_f32 v242, v242
    v_exp_f32 v243, v243
    v_exp_f32 v244, v244
    v_exp_f32 v245, v245
    v_pk_fma_f32 v[246:247], v[116:117], v[120:121], v[68:69] op_sel:[0,1,0] op_sel_hi:[1,1,1]
    v_pk_fma_f32 v[248:249], v[118:119], v[120:121], v[70:71] op_sel:[0,1,0] op_sel_hi:[1,1,1]
    v_pk_fma_f32 v[242:243], v[242:243], v[122:123], v[122:123] op_sel:[0,1,1] op_sel_hi:[1,1,1]
    v_pk_fma_f32 v[244:245], v[244:245], v[122:123], v[122:123] op_sel:[0,1,1] op_sel_hi:[1,1,1]
    v_rcp_f32 v242, v242
    v_rcp_f32 v243, v243
    v_rcp_f32 v244, v244
    v_rcp_f32 v245, v245
    v_pk_mul_f32 v[238:239], v[238:239], v[246:247] op_sel:[0,0] op_sel_hi:[1,1]
    v_pk_mul_f32 v[240:241], v[240:241], v[248:249] op_sel:[0,0] op_sel_hi:[1,1]
    v_pk_mul_f32 v[238:239], v[238:239], v[242:243] op_sel:[0,0] op_sel_hi:[1,1]
    v_pk_mul_f32 v[240:241], v[240:241], v[244:245] op_sel:[0,0] op_sel_hi:[1,1]
    v_cvt_pk_bf16_f32 v250, v238, v239
    v_cvt_pk_bf16_f32 v251, v240, v241
    s_add_u32 s3, s59, 32
    s_lshl_b32 s3, s3, 6
    s_add_u32 s3, s3, s75
    s_lshl_b32 s3, s3, 10
    s_lshl_b32 s4, s63, 3
    s_add_u32 s3, s3, s4
    buffer_store_dwordx2 v[250:251], v193, s[28:31], s3 offen sc1
K1_E_D:
    s_lshl_b32 s3, s52, 2
    s_lshr_b32 s65, 0x3527640, s3
    s_and_b32 s65, s65, 7
    s_lshr_b32 s66, 0x1111112, s3
    s_and_b32 s66, s66, 3
    s_cbranch_scc0 K1_ATT_END
K1_ATT:
    v_lshrrev_b32 v194, 4, v193
    v_and_b32 v186, 31, v194
    v_lshrrev_b32 v187, 5, v194
    s_lshr_b32 s3, s65, 1
    s_and_b32 s4, s65, 1
    v_mul_u32_u24 v188, 272, v186
    s_mul_i32 s5, s3, 8704
    s_add_u32 s5, s5, 544
    s_lshl_b32 s6, s4, 5
    s_add_u32 s6, s6, s5
    v_lshl_add_u32 v189, v187, 4, v188
    v_add_u32 v189, s6, v189
    s_lshl_b32 s6, s4, 6
    s_add_u32 s6, s6, s5
    v_lshl_add_u32 v190, v187, 5, v188
    v_add_u32 v190, s6, v190
    s_lshl_b32 s5, s3, 5
    s_add_u32 s5, s5, s57
    v_add_u32 v191, s5, v186
    v_lshlrev_b32 v192, 1, v187
    v_sub_u32 v191, v191, v192
    s_lshl_b32 s5, s56, 1
    s_add_u32 s5, s5, s4
    s_lshl_b32 s5, s5, 6
    s_lshl_b32 s6, s55, 2
    s_add_u32 s5, s5, s6
    s_add_u32 s5, s5, s3
    s_lshl_b32 s75, s5, 10
    ds_read_b128 v[0:3], v189 offset:3808
    ds_read_b128 v[4:7], v189 offset:3872
    ds_read_b128 v[8:11], v189 offset:3328
    ds_read_b128 v[12:15], v189 offset:2784
    ds_read_b128 v[16:19], v189 offset:2240
    ds_read_b128 v[20:23], v189 offset:1696
    ds_read_b128 v[24:27], v189 offset:1152
    ds_read_b128 v[28:31], v189 offset:608
    ds_read_b128 v[32:35], v189 offset:64
    ds_read_b128 v[36:39], v190 offset:3936
    ds_read_b128 v[40:43], v190 offset:3952
    ds_read_b128 v[44:47], v190 offset:3392
    ds_read_b128 v[48:51], v190 offset:3408
    ds_read_b128 v[52:55], v190 offset:2848
    ds_read_b128 v[56:59], v190 offset:2864
    s_waitcnt lgkmcnt(13)
    v_dot2_f32_bf16 v100, v0, v4, 0
    v_dot2_f32_bf16 v100, v1, v5, v100
    v_dot2_f32_bf16 v100, v2, v6, v100
    v_dot2_f32_bf16 v100, v3, v7, v100
    s_waitcnt lgkmcnt(12)
    v_dot2_f32_bf16 v101, v0, v8, 0
    v_dot2_f32_bf16 v101, v1, v9, v101
    v_dot2_f32_bf16 v101, v2, v10, v101
    v_dot2_f32_bf16 v101, v3, v11, v101
    s_waitcnt lgkmcnt(11)
    v_dot2_f32_bf16 v102, v0, v12, 0
    v_dot2_f32_bf16 v102, v1, v13, v102
    v_dot2_f32_bf16 v102, v2, v14, v102
    v_dot2_f32_bf16 v102, v3, v15, v102
    s_waitcnt lgkmcnt(10)
    v_dot2_f32_bf16 v103, v0, v16, 0
    v_dot2_f32_bf16 v103, v1, v17, v103
    v_dot2_f32_bf16 v103, v2, v18, v103
    v_dot2_f32_bf16 v103, v3, v19, v103
    s_waitcnt lgkmcnt(9)
    v_dot2_f32_bf16 v104, v0, v20, 0
    v_dot2_f32_bf16 v104, v1, v21, v104
    v_dot2_f32_bf16 v104, v2, v22, v104
    v_dot2_f32_bf16 v104, v3, v23, v104
    s_waitcnt lgkmcnt(8)
    v_dot2_f32_bf16 v105, v0, v24, 0
    v_dot2_f32_bf16 v105, v1, v25, v105
    v_dot2_f32_bf16 v105, v2, v26, v105
    v_dot2_f32_bf16 v105, v3, v27, v105
    s_waitcnt lgkmcnt(7)
    v_dot2_f32_bf16 v106, v0, v28, 0
    v_dot2_f32_bf16 v106, v1, v29, v106
    v_dot2_f32_bf16 v106, v2, v30, v106
    v_dot2_f32_bf16 v106, v3, v31, v106
    s_waitcnt lgkmcnt(6)
    v_dot2_f32_bf16 v107, v0, v32, 0
    v_dot2_f32_bf16 v107, v1, v33, v107
    v_dot2_f32_bf16 v107, v2, v34, v107
    v_dot2_f32_bf16 v107, v3, v35, v107
    ds_read_b128 v[60:63], v190 offset:2304
    ds_read_b128 v[64:67], v190 offset:2320
    ds_read_b128 v[68:71], v190 offset:1760
    ds_read_b128 v[72:75], v190 offset:1776
    ds_read_b128 v[76:79], v190 offset:1216
    ds_read_b128 v[80:83], v190 offset:1232
    ds_read_b128 v[84:87], v190 offset:672
    ds_read_b128 v[88:91], v190 offset:688
    ds_read_b128 v[92:95], v190 offset:128
    ds_read_b128 v[96:99], v190 offset:144
    s_nop 2
    v_permlane32_swap_b32 v100, v101
    v_permlane32_swap_b32 v102, v103
    v_permlane32_swap_b32 v104, v105
    v_permlane32_swap_b32 v106, v107
    v_mov_b32 v195, 0xce6e6b28
    v_add_f32 v100, v100, v101
    v_add_f32 v102, v102, v103
    v_add_f32 v104, v104, v105
    v_add_f32 v106, v106, v107
    v_cmp_le_i32 vcc, 0, v191
    v_mul_f32 v100, 0x3e800000, v100
    s_nop 0
    v_cndmask_b32 v100, v195, v100, vcc
    v_cmp_le_i32 vcc, 4, v191
    v_mul_f32 v102, 0x3e800000, v102
    s_nop 0
    v_cndmask_b32 v102, v195, v102, vcc
    v_cmp_le_i32 vcc, 8, v191
    v_mul_f32 v104, 0x3e800000, v104
    s_nop 0
    v_cndmask_b32 v104, v195, v104, vcc
    v_cmp_le_i32 vcc, 12, v191
    v_mul_f32 v106, 0x3e800000, v106
    s_nop 0
    v_cndmask_b32 v106, v195, v106, vcc
    v_max3_f32 v101, v100, v102, v104
    v_max_f32 v101, v101, v106
    v_mov_b32 v103, v101
    s_nop 1
    v_permlane32_swap_b32 v101, v103
    s_nop 0
    v_max_f32 v101, v101, v103
    v_sub_f32 v100, v100, v101
    v_sub_f32 v102, v102, v101
    v_sub_f32 v104, v104, v101
    v_sub_f32 v106, v106, v101
    v_mul_f32 v100, 0x3fb8aa3b, v100
    v_mul_f32 v102, 0x3fb8aa3b, v102
    v_mul_f32 v104, 0x3fb8aa3b, v104
    v_mul_f32 v106, 0x3fb8aa3b, v106
    v_exp_f32 v100, v100
    v_exp_f32 v102, v102
    v_exp_f32 v104, v104
    v_exp_f32 v106, v106
    s_nop 0
    v_add_f32 v101, v100, v102
    v_add_f32 v103, v104, v106
    v_add_f32 v101, v101, v103
    v_mov_b32 v103, v101
    s_nop 1
    v_permlane32_swap_b32 v101, v103
    s_nop 0
    v_add_f32 v108, v101, v103
    v_rcp_f32 v108, v108
    s_nop 0
    v_mul_f32 v100, v100, v108
    v_mul_f32 v102, v102, v108
    v_mul_f32 v104, v104, v108
    v_mul_f32 v106, v106, v108
    v_mov_b32 v101, v100
    v_mov_b32 v103, v102
    v_mov_b32 v105, v104
    v_mov_b32 v107, v106
    s_nop 1
    v_permlane32_swap_b32 v100, v101
    v_permlane32_swap_b32 v102, v103
    v_permlane32_swap_b32 v104, v105
    v_permlane32_swap_b32 v106, v107
    s_nop 0
    s_waitcnt lgkmcnt(14)
    v_pk_mul_f32 v[112:113], v[36:37], v[100:101] op_sel:[0,0] op_sel_hi:[1,0]
    v_pk_mul_f32 v[114:115], v[38:39], v[100:101] op_sel:[0,0] op_sel_hi:[1,0]
    v_pk_mul_f32 v[116:117], v[40:41], v[100:101] op_sel:[0,0] op_sel_hi:[1,0]
    v_pk_mul_f32 v[118:119], v[42:43], v[100:101] op_sel:[0,0] op_sel_hi:[1,0]
    s_waitcnt lgkmcnt(12)
    v_pk_fma_f32 v[112:113], v[44:45], v[100:101], v[112:113] op_sel:[0,1,0] op_sel_hi:[1,1,1]
    v_pk_fma_f32 v[114:115], v[46:47], v[100:101], v[114:115] op_sel:[0,1,0] op_sel_hi:[1,1,1]
    v_pk_fma_f32 v[116:117], v[48:49], v[100:101], v[116:117] op_sel:[0,1,0] op_sel_hi:[1,1,1]
    v_pk_fma_f32 v[118:119], v[50:51], v[100:101], v[118:119] op_sel:[0,1,0] op_sel_hi:[1,1,1]
    s_waitcnt lgkmcnt(10)
    v_pk_fma_f32 v[112:113], v[52:53], v[102:103], v[112:113] op_sel:[0,0,0] op_sel_hi:[1,0,1]
    v_pk_fma_f32 v[114:115], v[54:55], v[102:103], v[114:115] op_sel:[0,0,0] op_sel_hi:[1,0,1]
    v_pk_fma_f32 v[116:117], v[56:57], v[102:103], v[116:117] op_sel:[0,0,0] op_sel_hi:[1,0,1]
    v_pk_fma_f32 v[118:119], v[58:59], v[102:103], v[118:119] op_sel:[0,0,0] op_sel_hi:[1,0,1]
    s_waitcnt lgkmcnt(8)
    v_pk_fma_f32 v[112:113], v[60:61], v[102:103], v[112:113] op_sel:[0,1,0] op_sel_hi:[1,1,1]
    v_pk_fma_f32 v[114:115], v[62:63], v[102:103], v[114:115] op_sel:[0,1,0] op_sel_hi:[1,1,1]
    v_pk_fma_f32 v[116:117], v[64:65], v[102:103], v[116:117] op_sel:[0,1,0] op_sel_hi:[1,1,1]
    v_pk_fma_f32 v[118:119], v[66:67], v[102:103], v[118:119] op_sel:[0,1,0] op_sel_hi:[1,1,1]
    s_waitcnt lgkmcnt(6)
    v_pk_fma_f32 v[112:113], v[68:69], v[104:105], v[112:113] op_sel:[0,0,0] op_sel_hi:[1,0,1]
    v_pk_fma_f32 v[114:115], v[70:71], v[104:105], v[114:115] op_sel:[0,0,0] op_sel_hi:[1,0,1]
    v_pk_fma_f32 v[116:117], v[72:73], v[104:105], v[116:117] op_sel:[0,0,0] op_sel_hi:[1,0,1]
    v_pk_fma_f32 v[118:119], v[74:75], v[104:105], v[118:119] op_sel:[0,0,0] op_sel_hi:[1,0,1]
    s_waitcnt lgkmcnt(4)
    v_pk_fma_f32 v[112:113], v[76:77], v[104:105], v[112:113] op_sel:[0,1,0] op_sel_hi:[1,1,1]
    v_pk_fma_f32 v[114:115], v[78:79], v[104:105], v[114:115] op_sel:[0,1,0] op_sel_hi:[1,1,1]
    v_pk_fma_f32 v[116:117], v[80:81], v[104:105], v[116:117] op_sel:[0,1,0] op_sel_hi:[1,1,1]
    v_pk_fma_f32 v[118:119], v[82:83], v[104:105], v[118:119] op_sel:[0,1,0] op_sel_hi:[1,1,1]
    s_waitcnt lgkmcnt(2)
    v_pk_fma_f32 v[112:113], v[84:85], v[106:107], v[112:113] op_sel:[0,0,0] op_sel_hi:[1,0,1]
    v_pk_fma_f32 v[114:115], v[86:87], v[106:107], v[114:115] op_sel:[0,0,0] op_sel_hi:[1,0,1]
    v_pk_fma_f32 v[116:117], v[88:89], v[106:107], v[116:117] op_sel:[0,0,0] op_sel_hi:[1,0,1]
    v_pk_fma_f32 v[118:119], v[90:91], v[106:107], v[118:119] op_sel:[0,0,0] op_sel_hi:[1,0,1]
    s_waitcnt lgkmcnt(0)
    v_pk_fma_f32 v[112:113], v[92:93], v[106:107], v[112:113] op_sel:[0,1,0] op_sel_hi:[1,1,1]
    v_pk_fma_f32 v[114:115], v[94:95], v[106:107], v[114:115] op_sel:[0,1,0] op_sel_hi:[1,1,1]
    v_pk_fma_f32 v[116:117], v[96:97], v[106:107], v[116:117] op_sel:[0,1,0] op_sel_hi:[1,1,1]
    v_pk_fma_f32 v[118:119], v[98:99], v[106:107], v[118:119] op_sel:[0,1,0] op_sel_hi:[1,1,1]
    v_cvt_pk_bf16_f32 v120, v112, v113
    v_cvt_pk_bf16_f32 v121, v114, v115
    v_cvt_pk_bf16_f32 v122, v116, v117
    v_cvt_pk_bf16_f32 v123, v118, v119
    buffer_store_dwordx4 v[120:123], v193, s[28:31], s75 offen sc1
    s_add_u32 s65, s65, 1
    s_sub_u32 s66, s66, 1
    s_cmp_lg_u32 s66, 0
    s_cbranch_scc1 K1_ATT
K1_ATT_END:
    v_mov_b32 v248, v193
    s_nop 1
    buffer_load_dwordx4 v[112:115], v254, s[32:35], s19 offen sc1
    buffer_load_dwordx4 v[116:119], v254, s[32:35], s19 offen offset:1024 sc1
    s_add_u32 s19, s19, 131072
    buffer_load_dwordx4 v[120:123], v254, s[32:35], s19 offen sc1
    buffer_load_dwordx4 v[124:127], v254, s[32:35], s19 offen offset:1024 sc1
    s_add_u32 s19, s19, 131072
    v_add_u32 v249, s18, v248
    s_waitcnt vmcnt(4)
    s_barrier
    s_cmp_lg_u32 s52, 0
    s_cbranch_scc1 P2_NF
    s_lshl_b32 s3, s55, 7
    s_lshl_b32 s4, s56, 2
    s_add_u32 s3, s3, s4
    s_add_u32 s3, s3, 4096
    v_mov_b32 v252, s3
    v_mov_b32 v253, s100
    s_mov_b64 exec, 1
    buffer_store_dword v253, v252, s[40:43], 0 offen sc1
    s_mov_b64 exec, -1
P2_NF:
    ds_read_b128 v[64:67], v249 offset:0
    ds_read_b128 v[68:71], v249 offset:1024
    ds_read_b128 v[72:75], v249 offset:2048
    ds_read_b128 v[76:79], v249 offset:3072
    ds_read_b128 v[80:83], v249 offset:4096
    ds_read_b128 v[84:87], v249 offset:5120
    ds_read_b128 v[88:91], v249 offset:6144
    ds_read_b128 v[92:95], v249 offset:7168
    ds_read_b128 v[96:99], v249 offset:8192
    ds_read_b128 v[100:103], v249 offset:9216
    ds_read_b128 v[104:107], v249 offset:10240
    ds_read_b128 v[108:111], v249 offset:11264
    buffer_load_dwordx4 v[128:131], v254, s[32:35], s19 offen sc1
    buffer_load_dwordx4 v[132:135], v254, s[32:35], s19 offen offset:1024 sc1
    s_add_u32 s19, s19, 131072
    buffer_load_dwordx4 v[136:139], v254, s[32:35], s19 offen sc1
    buffer_load_dwordx4 v[140:143], v254, s[32:35], s19 offen offset:1024 sc1
    s_add_u32 s19, s19, 131072
    buffer_load_dwordx4 v[144:147], v254, s[32:35], s19 offen sc1
    buffer_load_dwordx4 v[148:151], v254, s[32:35], s19 offen offset:1024 sc1
    s_add_u32 s19, s19, 131072
    buffer_load_dwordx4 v[152:155], v254, s[32:35], s19 offen sc1
    buffer_load_dwordx4 v[156:159], v254, s[32:35], s19 offen offset:1024 sc1
    s_add_u32 s19, s19, 131072
    buffer_load_dwordx4 v[160:163], v254, s[32:35], s19 offen sc1
    buffer_load_dwordx4 v[164:167], v254, s[32:35], s19 offen offset:1024 sc1
    s_add_u32 s19, s19, 131072
    buffer_load_dwordx4 v[168:171], v254, s[32:35], s19 offen sc1
    buffer_load_dwordx4 v[172:175], v254, s[32:35], s19 offen offset:1024 sc1
    s_add_u32 s19, s19, 131072
    buffer_load_dwordx4 v[176:179], v254, s[32:35], s19 offen sc1
    buffer_load_dwordx4 v[180:183], v254, s[32:35], s19 offen offset:1024 sc1
    s_add_u32 s19, s19, 131072
    s_mov_b32 s8, s36
    s_and_b32 s9, s37, 0xffff
    s_mov_b32 s10, 2097152
    s_mov_b32 s11, 0x00020000
    s_mov_b32 s12, s96
    s_and_b32 s13, s97, 0xffff
    s_mov_b32 s14, 2097152
    s_mov_b32 s15, 0x00020000
    s_lshl_b32 s6, s16, 11
    v_add_u32 v249, s6, v248
    s_lshl_b32 s18, s52, 16
    v_bfe_u32 v252, v248, 4, 5
    v_lshrrev_b32 v251, 9, v248
    v_lshlrev_b32 v252, 10, v252
    v_lshl_add_u32 v251, v251, 3, v252
    s_lshl_b32 s3, s16, 16
    s_lshr_b32 s4, s52, 2
    s_lshl_b32 s4, s4, 15
    s_add_u32 s3, s3, s4
    s_lshl_b32 s4, s17, 7
    s_add_u32 s3, s3, s4
    s_and_b32 s4, s52, 3
    s_lshl_b32 s4, s4, 5
    s_add_u32 s3, s3, s4
    v_add_u32 v251, s3, v251
    buffer_load_dwordx2 v[240:241], v251, s[8:11], 0 offen offset:0
    buffer_load_dwordx2 v[242:243], v251, s[8:11], 0 offen offset:16
    s_cmp_lg_u32 s52, 0
    s_cbranch_scc1 P2_GO
    v_bfe_u32 v252, v248, 2, 6
    s_lshr_b32 s4, s16, 1
    s_lshl_b32 s4, s4, 7
    s_add_u32 s4, s4, 4096
    s_mov_b32 s3, 0
P2_POLL:
    buffer_load_dword v253, v252, s[40:43], s4 offen sc1
    s_add_u32 s3, s3, 1
    s_waitcnt vmcnt(0)
    v_cmp_ne_u32 vcc, s100, v253
    s_cmp_gt_u32 s3, 0x20000
    s_cbranch_scc1 P2_GO
    s_cbranch_vccz P2_GO
    s_sleep 1
    s_branch P2_POLL
P2_GO:
    s_waitcnt lgkmcnt(0)
    s_barrier
    buffer_load_dwordx4 v[184:187], v249, s[28:31], s18 offen sc1
    buffer_load_dwordx4 v[188:191], v249, s[28:31], s18 offen offset:1024 sc1
    s_add_u32 s18, s18, 524288
    buffer_load_dwordx4 v[192:195], v249, s[28:31], s18 offen sc1
    buffer_load_dwordx4 v[196:199], v249, s[28:31], s18 offen offset:1024 sc1
    s_add_u32 s18, s18, 524288
    buffer_load_dwordx4 v[200:203], v249, s[28:31], s18 offen sc1
    buffer_load_dwordx4 v[204:207], v249, s[28:31], s18 offen offset:1024 sc1
    s_add_u32 s18, s18, 524288
    buffer_load_dwordx4 v[208:211], v249, s[28:31], s18 offen sc1
    buffer_load_dwordx4 v[212:215], v249, s[28:31], s18 offen offset:1024 sc1
    s_add_u32 s18, s18, 524288
    buffer_load_dwordx4 v[216:219], v249, s[28:31], s18 offen sc1
    buffer_load_dwordx4 v[220:223], v249, s[28:31], s18 offen offset:1024 sc1
    s_add_u32 s18, s18, 524288
    buffer_load_dwordx4 v[224:227], v249, s[28:31], s18 offen sc1
    buffer_load_dwordx4 v[228:231], v249, s[28:31], s18 offen offset:1024 sc1
    s_add_u32 s18, s18, 524288
    buffer_load_dwordx4 v[232:235], v249, s[28:31], s18 offen sc1
    buffer_load_dwordx4 v[236:239], v249, s[28:31], s18 offen offset:1024 sc1
    s_add_u32 s18, s18, 524288
    s_waitcnt vmcnt(13)
    v_mfma_f32_32x32x16_bf16 v[0:15], v[64:67], v[184:187], 0
    v_mfma_f32_32x32x16_bf16 v[16:31], v[68:71], v[184:187], 0
    s_waitcnt vmcnt(12)
    v_mfma_f32_32x32x16_bf16 v[32:47], v[64:67], v[188:191], 0
    v_mfma_f32_32x32x16_bf16 v[48:63], v[68:71], v[188:191], 0
    buffer_load_dwordx4 v[184:187], v249, s[28:31], s18 offen sc1
    buffer_load_dwordx4 v[188:191], v249, s[28:31], s18 offen offset:1024 sc1
    s_add_u32 s18, s18, 524288
    s_waitcnt vmcnt(13)
    v_mfma_f32_32x32x16_bf16 v[0:15], v[72:75], v[192:195], v[0:15]
    v_mfma_f32_32x32x16_bf16 v[16:31], v[76:79], v[192:195], v[16:31]
    s_waitcnt vmcnt(12)
    v_mfma_f32_32x32x16_bf16 v[32:47], v[72:75], v[196:199], v[32:47]
    v_mfma_f32_32x32x16_bf16 v[48:63], v[76:79], v[196:199], v[48:63]
    buffer_load_dwordx4 v[192:195], v249, s[28:31], s18 offen sc1
    buffer_load_dwordx4 v[196:199], v249, s[28:31], s18 offen offset:1024 sc1
    s_add_u32 s18, s18, 524288
    s_waitcnt vmcnt(13)
    v_mfma_f32_32x32x16_bf16 v[0:15], v[80:83], v[200:203], v[0:15]
    v_mfma_f32_32x32x16_bf16 v[16:31], v[84:87], v[200:203], v[16:31]
    s_waitcnt vmcnt(12)
    v_mfma_f32_32x32x16_bf16 v[32:47], v[80:83], v[204:207], v[32:47]
    v_mfma_f32_32x32x16_bf16 v[48:63], v[84:87], v[204:207], v[48:63]
    buffer_load_dwordx4 v[200:203], v249, s[28:31], s18 offen sc1
    buffer_load_dwordx4 v[204:207], v249, s[28:31], s18 offen offset:1024 sc1
    s_add_u32 s18, s18, 524288
    s_waitcnt vmcnt(13)
    v_mfma_f32_32x32x16_bf16 v[0:15], v[88:91], v[208:211], v[0:15]
    v_mfma_f32_32x32x16_bf16 v[16:31], v[92:95], v[208:211], v[16:31]
    s_waitcnt vmcnt(12)
    v_mfma_f32_32x32x16_bf16 v[32:47], v[88:91], v[212:215], v[32:47]
    v_mfma_f32_32x32x16_bf16 v[48:63], v[92:95], v[212:215], v[48:63]
    buffer_load_dwordx4 v[208:211], v249, s[28:31], s18 offen sc1
    buffer_load_dwordx4 v[212:215], v249, s[28:31], s18 offen offset:1024 sc1
    s_add_u32 s18, s18, 524288
    s_waitcnt vmcnt(13)
    v_mfma_f32_32x32x16_bf16 v[0:15], v[96:99], v[216:219], v[0:15]
    v_mfma_f32_32x32x16_bf16 v[16:31], v[100:103], v[216:219], v[16:31]
    s_waitcnt vmcnt(12)
    v_mfma_f32_32x32x16_bf16 v[32:47], v[96:99], v[220:223], v[32:47]
    v_mfma_f32_32x32x16_bf16 v[48:63], v[100:103], v[220:223], v[48:63]
    buffer_load_dwordx4 v[216:219], v249, s[28:31], s18 offen sc1
    buffer_load_dwordx4 v[220:223], v249, s[28:31], s18 offen offset:1024 sc1
    s_add_u32 s18, s18, 524288
    s_waitcnt vmcnt(13)
    v_mfma_f32_32x32x16_bf16 v[0:15], v[104:107], v[224:227], v[0:15]
    v_mfma_f32_32x32x16_bf16 v[16:31], v[108:111], v[224:227], v[16:31]
    s_waitcnt vmcnt(12)
    v_mfma_f32_32x32x16_bf16 v[32:47], v[104:107], v[228:231], v[32:47]
    v_mfma_f32_32x32x16_bf16 v[48:63], v[108:111], v[228:231], v[48:63]
    buffer_load_dwordx4 v[224:227], v249, s[28:31], s18 offen sc1
    buffer_load_dwordx4 v[228:231], v249, s[28:31], s18 offen offset:1024 sc1
    s_add_u32 s18, s18, 524288
    s_waitcnt vmcnt(13)
    v_mfma_f32_32x32x16_bf16 v[0:15], v[112:115], v[232:235], v[0:15]
    v_mfma_f32_32x32x16_bf16 v[16:31], v[116:119], v[232:235], v[16:31]
    s_waitcnt vmcnt(12)
    v_mfma_f32_32x32x16_bf16 v[32:47], v[112:115], v[236:239], v[32:47]
    v_mfma_f32_32x32x16_bf16 v[48:63], v[116:119], v[236:239], v[48:63]
    buffer_load_dwordx4 v[232:235], v249, s[28:31], s18 offen sc1
    buffer_load_dwordx4 v[236:239], v249, s[28:31], s18 offen offset:1024 sc1
    s_add_u32 s18, s18, 524288
    s_waitcnt vmcnt(13)
    v_mfma_f32_32x32x16_bf16 v[0:15], v[120:123], v[184:187], v[0:15]
    v_mfma_f32_32x32x16_bf16 v[16:31], v[124:127], v[184:187], v[16:31]
    s_waitcnt vmcnt(12)
    v_mfma_f32_32x32x16_bf16 v[32:47], v[120:123], v[188:191], v[32:47]
    v_mfma_f32_32x32x16_bf16 v[48:63], v[124:127], v[188:191], v[48:63]
    buffer_load_dwordx4 v[184:187], v249, s[28:31], s18 offen sc1
    buffer_load_dwordx4 v[188:191], v249, s[28:31], s18 offen offset:1024 sc1
    s_add_u32 s18, s18, 524288
    s_waitcnt vmcnt(13)
    v_mfma_f32_32x32x16_bf16 v[0:15], v[128:131], v[192:195], v[0:15]
    v_mfma_f32_32x32x16_bf16 v[16:31], v[132:135], v[192:195], v[16:31]
    s_waitcnt vmcnt(12)
    v_mfma_f32_32x32x16_bf16 v[32:47], v[128:131], v[196:199], v[32:47]
    v_mfma_f32_32x32x16_bf16 v[48:63], v[132:135], v[196:199], v[48:63]
    s_waitcnt vmcnt(11)
    v_mfma_f32_32x32x16_bf16 v[0:15], v[136:139], v[200:203], v[0:15]
    v_mfma_f32_32x32x16_bf16 v[16:31], v[140:143], v[200:203], v[16:31]
    s_waitcnt vmcnt(10)
    v_mfma_f32_32x32x16_bf16 v[32:47], v[136:139], v[204:207], v[32:47]
    v_mfma_f32_32x32x16_bf16 v[48:63], v[140:143], v[204:207], v[48:63]
    s_waitcnt vmcnt(9)
    v_mfma_f32_32x32x16_bf16 v[0:15], v[144:147], v[208:211], v[0:15]
    v_mfma_f32_32x32x16_bf16 v[16:31], v[148:151], v[208:211], v[16:31]
    s_waitcnt vmcnt(8)
    v_mfma_f32_32x32x16_bf16 v[32:47], v[144:147], v[212:215], v[32:47]
    v_mfma_f32_32x32x16_bf16 v[48:63], v[148:151], v[212:215], v[48:63]
    s_waitcnt vmcnt(7)
    v_mfma_f32_32x32x16_bf16 v[0:15], v[152:155], v[216:219], v[0:15]
    v_mfma_f32_32x32x16_bf16 v[16:31], v[156:159], v[216:219], v[16:31]
    s_waitcnt vmcnt(6)
    v_mfma_f32_32x32x16_bf16 v[32:47], v[152:155], v[220:223], v[32:47]
    v_mfma_f32_32x32x16_bf16 v[48:63], v[156:159], v[220:223], v[48:63]
    s_waitcnt vmcnt(5)
    v_mfma_f32_32x32x16_bf16 v[0:15], v[160:163], v[224:227], v[0:15]
    v_mfma_f32_32x32x16_bf16 v[16:31], v[164:167], v[224:227], v[16:31]
    s_waitcnt vmcnt(4)
    v_mfma_f32_32x32x16_bf16 v[32:47], v[160:163], v[228:231], v[32:47]
    v_mfma_f32_32x32x16_bf16 v[48:63], v[164:167], v[228:231], v[48:63]
    s_waitcnt vmcnt(3)
    v_mfma_f32_32x32x16_bf16 v[0:15], v[168:171], v[232:235], v[0:15]
    v_mfma_f32_32x32x16_bf16 v[16:31], v[172:175], v[232:235], v[16:31]
    s_waitcnt vmcnt(2)
    v_mfma_f32_32x32x16_bf16 v[32:47], v[168:171], v[236:239], v[32:47]
    v_mfma_f32_32x32x16_bf16 v[48:63], v[172:175], v[236:239], v[48:63]
    s_waitcnt vmcnt(1)
    v_mfma_f32_32x32x16_bf16 v[0:15], v[176:179], v[184:187], v[0:15]
    v_mfma_f32_32x32x16_bf16 v[16:31], v[180:183], v[184:187], v[16:31]
    s_waitcnt vmcnt(0)
    v_mfma_f32_32x32x16_bf16 v[32:47], v[176:179], v[188:191], v[32:47]
    v_mfma_f32_32x32x16_bf16 v[48:63], v[180:183], v[188:191], v[48:63]
    s_lshl_b32 s3, s52, 10
    v_add_u32 v252, s3, v248
    v_add_u32 v254, 0x10000, v252
    s_lshl_b32 s3, s52, 14
    v_add_u32 v253, s3, v248
    s_nop 7
    ds_write_b128 v252, v[0:3] offset:0
    ds_write_b128 v252, v[4:7] offset:8192
    ds_write_b128 v252, v[8:11] offset:16384
    ds_write_b128 v252, v[12:15] offset:24576
    ds_write_b128 v252, v[16:19] offset:32768
    ds_write_b128 v252, v[20:23] offset:40960
    ds_write_b128 v252, v[24:27] offset:49152
    ds_write_b128 v252, v[28:31] offset:57344
    ds_write_b128 v254, v[32:35] offset:0
    ds_write_b128 v254, v[36:39] offset:8192
    ds_write_b128 v254, v[40:43] offset:16384
    ds_write_b128 v254, v[44:47] offset:24576
    ds_write_b128 v254, v[48:51] offset:32768
    ds_write_b128 v254, v[52:55] offset:40960
    ds_write_b128 v254, v[56:59] offset:49152
    ds_write_b128 v254, v[60:63] offset:57344
    s_waitcnt lgkmcnt(0)
    s_barrier
    ds_read_b128 v[64:67], v253 offset:0
    ds_read_b128 v[68:71], v253 offset:8192
    ds_read_b128 v[72:75], v253 offset:1024
    ds_read_b128 v[76:79], v253 offset:9216
    ds_read_b128 v[80:83], v253 offset:2048
    ds_read_b128 v[84:87], v253 offset:10240
    ds_read_b128 v[88:91], v253 offset:3072
    ds_read_b128 v[92:95], v253 offset:11264
    ds_read_b128 v[96:99], v253 offset:4096
    ds_read_b128 v[100:103], v253 offset:12288
    ds_read_b128 v[104:107], v253 offset:5120
    ds_read_b128 v[108:111], v253 offset:13312
    ds_read_b128 v[112:115], v253 offset:6144
    ds_read_b128 v[116:119], v253 offset:14336
    ds_read_b128 v[120:123], v253 offset:7168
    ds_read_b128 v[124:127], v253 offset:15360
    v_lshlrev_b32 v0, 16, v240
    v_and_b32 v1, 0xffff0000, v240
    v_lshlrev_b32 v2, 16, v241
    v_and_b32 v3, 0xffff0000, v241
    v_lshlrev_b32 v4, 16, v242
    v_and_b32 v5, 0xffff0000, v242
    v_lshlrev_b32 v6, 16, v243
    v_and_b32 v7, 0xffff0000, v243
    s_waitcnt lgkmcnt(14)
    v_pk_add_f32 v[0:1], v[0:1], v[64:65]
    v_pk_add_f32 v[2:3], v[2:3], v[66:67]
    v_pk_add_f32 v[4:5], v[4:5], v[68:69]
    v_pk_add_f32 v[6:7], v[6:7], v[70:71]
    s_waitcnt lgkmcnt(12)
    v_pk_add_f32 v[0:1], v[0:1], v[72:73]
    v_pk_add_f32 v[2:3], v[2:3], v[74:75]
    v_pk_add_f32 v[4:5], v[4:5], v[76:77]
    v_pk_add_f32 v[6:7], v[6:7], v[78:79]
    s_waitcnt lgkmcnt(10)
    v_pk_add_f32 v[0:1], v[0:1], v[80:81]
    v_pk_add_f32 v[2:3], v[2:3], v[82:83]
    v_pk_add_f32 v[4:5], v[4:5], v[84:85]
    v_pk_add_f32 v[6:7], v[6:7], v[86:87]
    s_waitcnt lgkmcnt(8)
    v_pk_add_f32 v[0:1], v[0:1], v[88:89]
    v_pk_add_f32 v[2:3], v[2:3], v[90:91]
    v_pk_add_f32 v[4:5], v[4:5], v[92:93]
    v_pk_add_f32 v[6:7], v[6:7], v[94:95]
    s_waitcnt lgkmcnt(6)
    v_pk_add_f32 v[0:1], v[0:1], v[96:97]
    v_pk_add_f32 v[2:3], v[2:3], v[98:99]
    v_pk_add_f32 v[4:5], v[4:5], v[100:101]
    v_pk_add_f32 v[6:7], v[6:7], v[102:103]
    s_waitcnt lgkmcnt(4)
    v_pk_add_f32 v[0:1], v[0:1], v[104:105]
    v_pk_add_f32 v[2:3], v[2:3], v[106:107]
    v_pk_add_f32 v[4:5], v[4:5], v[108:109]
    v_pk_add_f32 v[6:7], v[6:7], v[110:111]
    s_waitcnt lgkmcnt(2)
    v_pk_add_f32 v[0:1], v[0:1], v[112:113]
    v_pk_add_f32 v[2:3], v[2:3], v[114:115]
    v_pk_add_f32 v[4:5], v[4:5], v[116:117]
    v_pk_add_f32 v[6:7], v[6:7], v[118:119]
    s_waitcnt lgkmcnt(0)
    v_pk_add_f32 v[0:1], v[0:1], v[120:121]
    v_pk_add_f32 v[2:3], v[2:3], v[122:123]
    v_pk_add_f32 v[4:5], v[4:5], v[124:125]
    v_pk_add_f32 v[6:7], v[6:7], v[126:127]
    v_cvt_pk_bf16_f32 v240, v0, v1
    v_cvt_pk_bf16_f32 v241, v2, v3
    v_cvt_pk_bf16_f32 v242, v4, v5
    v_cvt_pk_bf16_f32 v243, v6, v7
    buffer_store_dwordx2 v[240:241], v251, s[12:15], 0 offen offset:0
    buffer_store_dwordx2 v[242:243], v251, s[12:15], 0 offen offset:16
K1_END:
    s_endpgm
.section .rodata,"a"
.p2align 6
.amdhsa_kernel k1_kernel
  .amdhsa_next_free_vgpr 256
  .amdhsa_next_free_sgpr 102
  .amdhsa_accum_offset 256
  .amdhsa_group_segment_fixed_size 0
  .amdhsa_kernarg_size 80
  .amdhsa_user_sgpr_count 2
  .amdhsa_user_sgpr_kernarg_segment_ptr 1
  .amdhsa_system_sgpr_workgroup_id_x 1
.end_amdhsa_kernel
```
